```python
import torch

def _softmax(x, axis=-1):
    return torch.softmax(x, dim=axis)
def _gelu(x):
    return torch.nn.functional.gelu(x, approximate="tanh")
def _silu(x):
    return torch.nn.functional.silu(x)
def _sigmoid(x):
    return torch.sigmoid(x)
def _layernorm(x, axis=-1, eps=1e-5):
    m = x.mean(dim=axis, keepdim=True)
    v = x.var(dim=axis, keepdim=True, unbiased=False)
    return (x - m) / torch.sqrt(v + eps)
def _scatter_add(tgt, idx, src, axis=0):
    return tgt.clone().index_add_(axis, idx, src)
def _segment_sum(src, seg, n):
    out = torch.zeros((n,) + src.shape[1:], dtype=src.dtype)
    return out.index_add_(0, seg, src)
def _pad(x, pw):
    flat = tuple(v for pair in reversed(pw) for v in pair)
    return torch.nn.functional.pad(x, flat)

kernel_name = 'gated_mix__softmax_full_mha__swiglu_ffn__prompt'

def setup_inputs():

    _w = (lambda a: (lambda t: t.to(torch.bfloat16) if t.is_floating_point() else t)(torch.as_tensor(a)))
    def _A_setup():
        B, S, D = 1, 2048, 448
        return {
            "x": _w((lambda *s: torch.randn(*s, dtype=torch.bfloat16) * 0.05)(B, S, D)),
            "wqkv": _w((lambda *s: torch.randn(*s, dtype=torch.bfloat16) * 0.8)(D, 3 * D)),
            "wo": _w((lambda *s: torch.randn(*s, dtype=torch.bfloat16) * 0.05)(D, D)),
        }
    _A_in = _A_setup()

    def _B_setup():
        B, S, D, F = 1, 2048, 448, 1792
        return {
            "x": _w((lambda *s: torch.randn(*s, dtype=torch.bfloat16) * 0.05)(B, S, D)),
            "w_gate": _w((lambda *s: torch.randn(*s, dtype=torch.bfloat16) * 0.1)(D, F)),
            "w_up": _w((lambda *s: torch.randn(*s, dtype=torch.bfloat16) * 0.1)(D, F)),
            "w_down": _w((lambda *s: torch.randn(*s, dtype=torch.bfloat16) * 0.1)(F, D)),
        }
    _B_in = _B_setup()

    return {
        "A_x": _A_in["x"],
        "A_wqkv": _A_in["wqkv"],
        "A_wo": _A_in["wo"],
        "B_x": _B_in["x"],
        "B_w_gate": _B_in["w_gate"],
        "B_w_up": _B_in["w_up"],
        "B_w_down": _B_in["w_down"],
        "gate_w": _w((lambda *s: torch.randn(*s, dtype=torch.bfloat16) * 0.05)(448) * 16.0),
    }

def reference(A_x, A_wqkv, A_wo, B_x, B_w_gate, B_w_up, B_w_down, gate_w):
    def _A_ref(x, wqkv, wo):
        B, S, D = x.shape
        H = 16; Dh = D // H
        qkv = (lambda x, *d: x.permute(*d))((x @ wqkv).reshape(B, S, 3, H, Dh), 2, 0, 3, 1, 4)
        q, k, v = qkv[0], qkv[1], qkv[2]
        scale = Dh ** -0.5
        scores = torch.einsum("bhqd,bhkd->bhqk", q, k) * scale
        p = _softmax(scores, axis=-1)
        o = torch.einsum("bhqk,bhkd->bhqd", p, v)
        return (lambda x, *d: x.permute(*d))(o, 0, 2, 1, 3).reshape(B, S, D) @ wo

    def _B_ref(x, w_gate, w_up, w_down):
        g = _silu(x @ w_gate)
        u = x @ w_up
        return (g * u) @ w_down

    x = A_x
    g = _sigmoid((x * gate_w).sum(-1, keepdims=True))
    a = _A_ref(x, A_wqkv, A_wo)
    b = _B_ref(x, B_w_gate, B_w_up, B_w_down)
    return g * a + (1 - g) * b
```

```asm
; @launch grid=(256,1,1) block=(512,1,1) lds=163840
.amdgcn_target "amdgcn-amd-amdhsa--gfx950"
.text
.globl gated_mix__softmax_full_mha__swiglu_ffn__prompt_kernel
.p2align 8
.type gated_mix__softmax_full_mha__swiglu_ffn__prompt_kernel,@function
gated_mix__softmax_full_mha__swiglu_ffn__prompt_kernel:
    s_cmp_ge_u32 s2, 256
    s_cbranch_scc1 k_end
    s_load_dwordx16 s[64:79], s[0:1], 0
    s_load_dwordx4 s[80:83], s[0:1], 64
    s_load_dwordx2 s[84:85], s[0:1], 80
    v_and_b32 v1, 63, v0
    v_lshrrev_b32 v3, 6, v0
    s_and_b32 s61, s2, 7
    s_lshr_b32 s62, s2, 3
    v_readfirstlane_b32 s38, v3
    s_lshr_b32 s43, s61, 1
    s_mul_i32 s42, s43, 28
    s_sub_u32 s42, s42, 4
    s_lshl_b32 s43, s43, 2
    s_add_u32 s43, s43, 112
    s_cmp_lt_u32 s62, 4
    s_cselect_b32 s42, s43, s42
    s_add_u32 s42, s42, s62
    s_lshr_b32 s37, s42, 3
    s_and_b32 s42, s42, 7
    s_and_b32 s36, s61, 1
    s_lshl_b32 s36, s36, 3
    s_add_u32 s36, s36, s42
    v_lshrrev_b32 v3, 3, v1
    v_lshrrev_b32 v4, 4, v1
    v_and_b32 v5, 7, v1
    v_xor_b32 v6, v5, v4
    s_lshl_b32 s42, s36, 7
    s_lshl_b32 s43, s38, 4
    s_add_u32 s42, s42, s43
    v_add_u32 v7, s42, v3
    v_mul_u32_u24 v7, 896, v7
    v_lshl_add_u32 v7, v6, 4, v7
    v_xor_b32 v8, 64, v7
    v_add_u32 v8, 7168, v8
    v_and_b32 v6, 1, v4
    v_lshlrev_b32 v6, 2, v6
    v_xor_b32 v6, v6, v5
    v_lshlrev_b32 v6, 4, v6
    v_mul_u32_u24 v31, 896, v3
    v_add_u32 v31, v31, v6
    s_lshl_b32 s42, s38, 3
    v_add_u32 v3, s42, v3
    v_mul_u32_u24 v9, 2688, v3
    v_add_u32 v9, v9, v6
    s_lshl_b32 s45, s38, 11
    s_lshl_b32 s46, s38, 10
    s_add_u32 s46, s46, 16384
    v_lshlrev_b32 v2, 4, v1
    s_mov_b32 s6, 1835008
    s_mov_b32 s7, 0x00020000
    s_mov_b32 s10, 1204224
    s_mov_b32 s11, 0x00020000
    s_mov_b32 s15, 0x00020000
    s_mov_b32 s19, 0x00020000
    s_cmp_ge_u32 s37, 14
    s_cbranch_scc1 k1_v
    s_lshl_b32 s42, s37, 7
    v_add_u32 v9, s42, v9
    v_mul_u32_u24 v10, 3584, v3
    s_lshl_b32 s42, s37, 8
    v_add3_u32 v10, v10, v6, s42
    v_xor_b32 v11, 32, v10
    s_mov_b32 s14, 1605632
    s_mov_b32 s18, 1605632
    s_waitcnt lgkmcnt(0)
    s_mov_b64 s[4:5], s[64:65]
    s_mov_b64 s[8:9], s[66:67]
    s_mov_b64 s[12:13], s[72:73]
    s_mov_b64 s[16:17], s[74:75]
    s_add_u32 m0, s45, 0
    s_mov_b32 s47, 0
    buffer_load_dwordx4 v7, s[4:7], s47 offen lds
    s_add_u32 m0, s45, 1024
    s_mov_b32 s47, 0
    buffer_load_dwordx4 v8, s[4:7], s47 offen lds
    s_add_u32 m0, s46, 0
    s_mov_b32 s47, 0
    buffer_load_dwordx4 v9, s[8:11], s47 offen lds
    s_add_u32 m0, s46, 8192
    s_mov_b32 s47, 0
    buffer_load_dwordx4 v10, s[12:15], s47 offen lds
    s_add_u32 m0, s46, 16384
    s_mov_b32 s47, 0
    buffer_load_dwordx4 v11, s[16:19], s47 offen lds
    s_barrier
    s_lshl_b32 s58, s2, 3
    s_add_u32 s58, s58, s38
    s_lshl_b32 s42, s58, 10
    s_mov_b32 s27, 0x00020000
    v_lshrrev_b32 v30, 3, v1
    v_lshlrev_b32 v30, 7, v30
    v_add_u32 v30, v30, v2
    s_cmp_lt_u32 s58, 672
    s_cbranch_scc1 k_pf_q_f
    s_cmp_lt_u32 s58, 1120
    s_cselect_b32 s24, s72, s74
    s_cselect_b32 s25, s73, s75
    s_cselect_b32 s42, 0, 448
    s_mov_b32 s26, 1605632
    s_sub_u32 s42, s58, s42
    s_lshl_b32 s42, s42, 11
    s_add_u32 s42, s42, 4294279168
    buffer_load_dwordx4 v[208:211], v30, s[24:27], s42 offen
    s_branch k_pf_d_f
k_pf_q_f:
    s_add_u32 s42, s42, 516096
    buffer_load_dwordx4 v[208:211], v2, s[8:11], s42 offen
k_pf_d_f:
    s_add_u32 m0, s45, 40960
    s_mov_b32 s47, 128
    buffer_load_dwordx4 v7, s[4:7], s47 offen lds
    s_add_u32 m0, s45, 41984
    s_mov_b32 s47, 128
    buffer_load_dwordx4 v8, s[4:7], s47 offen lds
    s_add_u32 m0, s46, 40960
    s_mov_b32 s47, 172032
    buffer_load_dwordx4 v9, s[8:11], s47 offen lds
    s_add_u32 m0, s46, 49152
    s_mov_b32 s47, 229376
    buffer_load_dwordx4 v10, s[12:15], s47 offen lds
    s_add_u32 m0, s46, 57344
    s_mov_b32 s47, 229376
    buffer_load_dwordx4 v11, s[16:19], s47 offen lds
    s_mov_b32 s20, s84
    s_mov_b32 s21, s85
    s_mov_b32 s22, 33554432
    s_mov_b32 s23, 0x00020000
    s_mov_b32 s32, s82
    s_mov_b32 s33, s83
    s_mov_b32 s34, 256
    s_mov_b32 s35, 0x00020000
    s_mov_b32 s28, s76
    s_mov_b32 s29, s77
    s_mov_b32 s30, 1605632
    s_mov_b32 s31, 0x00020000
    s_or_b32 s42, s2, s38
    s_cmp_lg_u32 s42, 0
    s_cbranch_scc1 k_nononce_f
    s_memrealtime s[48:49]
    v_mov_b32 v4, 0
    s_waitcnt lgkmcnt(0)
    s_or_b32 s42, s48, 0x80000000
    v_mov_b32 v3, s42
    s_mov_b64 exec, 1
    buffer_store_dword v3, v4, s[32:35], 0 offen sc1
    s_mov_b64 exec, -1
k_nononce_f:
    s_cmp_lt_u32 s58, 784
    s_cselect_b32 s24, s72, s74
    s_cselect_b32 s25, s73, s75
    s_cselect_b32 s42, 0, 784
    s_mov_b32 s26, 1605632
    s_sub_u32 s42, s58, s42
    s_lshl_b32 s42, s42, 11
    buffer_load_dwordx4 v[212:215], v30, s[24:27], s42 offen offset:128
    s_cmp_lt_u32 s58, 1568
    s_cselect_b32 s24, s76, s68
    s_cselect_b32 s25, s77, s69
    s_cselect_b32 s42, 0, 1568
    s_cselect_b32 s26, s30, 401408
    s_sub_u32 s42, s58, s42
    s_lshl_b32 s42, s42, 10
    buffer_load_dwordx4 v[216:219], v2, s[24:27], s42 offen
    s_sub_u32 s42, s62, 28
    s_cmp_ge_u32 s42, 4
    s_cbranch_scc1 k_nocp_f
    s_lshl_b32 s42, s42, 3
    s_add_u32 s42, s42, s38
    s_lshl_b32 s42, s42, 10
    v_add_u32 v3, s42, v2
    v_min_u32 v3, k_end-gated_mix__softmax_full_mha__swiglu_ffn__prompt_kernel-12, v3
    s_getpc_b64 s[48:49]
k_pc_f:
    s_sub_u32 s48, s48, k_pc_f-gated_mix__softmax_full_mha__swiglu_ffn__prompt_kernel
    s_subb_u32 s49, s49, 0
    v_mov_b32 v5, s49
    v_add_co_u32 v4, vcc, s48, v3
    s_nop 1
    v_addc_co_u32 v5, vcc, 0, v5, vcc
    global_load_dwordx4 v[220:223], v[4:5], off
k_nocp_f:
    s_and_b32 s39, s38, 3
    s_lshr_b32 s40, s38, 2
    s_lshl_b32 s49, s36, 2
    s_add_u32 s49, s49, s39
    v_and_b32 v3, 31, v1
    v_lshrrev_b32 v4, 5, v1
    v_bfe_u32 v5, v1, 1, 3
    v_xor_b32 v5, v5, v4
    s_lshl_b32 s42, s39, 12
    v_lshlrev_b32 v6, 7, v3
    v_lshl_add_u32 v6, v5, 4, v6
    v_add_u32 v14, s42, v6
    v_xor_b32 v15, 32, v14
    v_xor_b32 v16, 64, v14
    v_xor_b32 v17, 96, v14
    v_bfe_u32 v26, v1, 4, 1
    v_bfe_u32 v27, v1, 2, 2
    v_and_b32 v28, 3, v1
    v_lshl_add_u32 v29, v4, 3, v27
    v_and_b32 v5, 2, v27
    v_xor_b32 v5, v5, v26
    s_lshl_b32 s42, s40, 1
    v_xor_b32 v5, s42, v5
    v_lshlrev_b32 v6, 7, v29
    v_lshl_add_u32 v6, v5, 5, v6
    v_lshl_add_u32 v6, v28, 3, v6
    v_add_u32 v18, 16384, v6
    s_mov_b32 s60, 0xbfb8aa3b
    v_lshl_add_u32 v19, v26, 13, v6
    v_add_u32 v19, 24576, v19
    v_xor_b32 v20, 32, v19
    s_cmp_ge_u32 s37, 7
    s_cselect_b32 s43, 2068480, 0
    s_cselect_b32 s48, 1.0, 0x3e8b97f6
    s_lshl_b32 s44, s37, 12
    s_add_u32 s43, s43, s44
    s_lshl_b32 s44, s40, 11
    s_add_u32 s43, s43, s44
    s_mul_i32 s52, s49, 28672
    s_add_u32 s52, s52, s43
    s_mul_i32 s50, s49, 112
    s_lshl_b32 s43, s37, 3
    s_add_u32 s50, s50, s43
    s_lshl_b32 s43, s40, 1
    s_add_u32 s50, s50, s43
    s_lshl_b32 s50, s50, 10
    s_add_u32 s50, s50, 6291456
    s_add_u32 s51, s50, 4096
    s_waitcnt vmcnt(8)
    s_barrier
    ds_read_b128 v[32:35], v14 offset:0
    ds_read_b64_tr_b16 v[224:225], v18 offset:0
    ds_read_b64_tr_b16 v[226:227], v18 offset:512
    ds_read_b64_tr_b16 v[228:229], v19 offset:0
    ds_read_b64_tr_b16 v[230:231], v19 offset:512
    ds_read_b64_tr_b16 v[232:233], v20 offset:0
    ds_read_b64_tr_b16 v[234:235], v20 offset:512
    ds_read_b128 v[36:39], v15 offset:0
    ds_read_b64_tr_b16 v[236:237], v18 offset:2048
    ds_read_b64_tr_b16 v[238:239], v18 offset:2560
    ds_read_b64_tr_b16 v[240:241], v19 offset:2048
    ds_read_b64_tr_b16 v[242:243], v19 offset:2560
    ds_read_b64_tr_b16 v[244:245], v20 offset:2048
    ds_read_b64_tr_b16 v[246:247], v20 offset:2560
    s_waitcnt lgkmcnt(7)
    v_mfma_f32_32x32x16_bf16 v[144:159], v[224:227], v[32:35], 0
    ds_read_b128 v[40:43], v16 offset:0
    ds_read_b64_tr_b16 v[192:193], v18 offset:4096
    ds_read_b64_tr_b16 v[194:195], v18 offset:4608
    v_mfma_f32_32x32x16_bf16 v[160:175], v[228:231], v[32:35], 0
    ds_read_b64_tr_b16 v[196:197], v19 offset:4096
    ds_read_b64_tr_b16 v[198:199], v19 offset:4608
    ds_read_b64_tr_b16 v[200:201], v20 offset:4096
    ds_read_b64_tr_b16 v[202:203], v20 offset:4608
    v_mfma_f32_32x32x16_bf16 v[176:191], v[232:235], v[32:35], 0
    s_add_u32 m0, s45, 81920
    s_mov_b32 s47, 256
    buffer_load_dwordx4 v7, s[4:7], s47 offen lds
    s_add_u32 m0, s45, 82944
    s_mov_b32 s47, 256
    buffer_load_dwordx4 v8, s[4:7], s47 offen lds
    s_waitcnt lgkmcnt(7)
    v_mfma_f32_32x32x16_bf16 v[144:159], v[236:239], v[36:39], v[144:159]
    ds_read_b128 v[44:47], v17 offset:0
    ds_read_b64_tr_b16 v[224:225], v18 offset:6144
    ds_read_b64_tr_b16 v[226:227], v18 offset:6656
    v_mfma_f32_32x32x16_bf16 v[160:175], v[240:243], v[36:39], v[160:175]
    ds_read_b64_tr_b16 v[228:229], v19 offset:6144
    ds_read_b64_tr_b16 v[230:231], v19 offset:6656
    ds_read_b64_tr_b16 v[232:233], v20 offset:6144
    ds_read_b64_tr_b16 v[234:235], v20 offset:6656
    v_mfma_f32_32x32x16_bf16 v[176:191], v[244:247], v[36:39], v[176:191]
    s_add_u32 m0, s46, 81920
    s_mov_b32 s47, 344064
    buffer_load_dwordx4 v9, s[8:11], s47 offen lds
    s_add_u32 m0, s46, 90112
    s_mov_b32 s47, 458752
    buffer_load_dwordx4 v10, s[12:15], s47 offen lds
    s_waitcnt vmcnt(6) lgkmcnt(0)
    s_barrier
    v_mfma_f32_32x32x16_bf16 v[144:159], v[192:195], v[40:43], v[144:159]
    ds_read_b128 v[48:51], v14 offset:40960
    ds_read_b64_tr_b16 v[236:237], v18 offset:40960
    ds_read_b64_tr_b16 v[238:239], v18 offset:41472
    v_mfma_f32_32x32x16_bf16 v[160:175], v[196:199], v[40:43], v[160:175]
    ds_read_b64_tr_b16 v[240:241], v19 offset:40960
    ds_read_b64_tr_b16 v[242:243], v19 offset:41472
    ds_read_b64_tr_b16 v[244:245], v20 offset:40960
    ds_read_b64_tr_b16 v[246:247], v20 offset:41472
    v_mfma_f32_32x32x16_bf16 v[176:191], v[200:203], v[40:43], v[176:191]
    s_add_u32 m0, s46, 98304
    s_mov_b32 s47, 458752
    buffer_load_dwordx4 v11, s[16:19], s47 offen lds
    s_add_u32 m0, s45, 122880
    s_mov_b32 s47, 384
    buffer_load_dwordx4 v7, s[4:7], s47 offen lds
    s_waitcnt lgkmcnt(7)
    v_mfma_f32_32x32x16_bf16 v[144:159], v[224:227], v[44:47], v[144:159]
    ds_read_b128 v[52:55], v15 offset:40960
    ds_read_b64_tr_b16 v[192:193], v18 offset:43008
    ds_read_b64_tr_b16 v[194:195], v18 offset:43520
    v_mfma_f32_32x32x16_bf16 v[160:175], v[228:231], v[44:47], v[160:175]
    ds_read_b64_tr_b16 v[196:197], v19 offset:43008
    ds_read_b64_tr_b16 v[198:199], v19 offset:43520
    ds_read_b64_tr_b16 v[200:201], v20 offset:43008
    ds_read_b64_tr_b16 v[202:203], v20 offset:43520
    v_mfma_f32_32x32x16_bf16 v[176:191], v[232:235], v[44:47], v[176:191]
    s_add_u32 m0, s45, 123904
    s_mov_b32 s47, 384
    buffer_load_dwordx4 v8, s[4:7], s47 offen lds
    s_add_u32 m0, s46, 122880
    s_mov_b32 s47, 516096
    buffer_load_dwordx4 v9, s[8:11], s47 offen lds
    s_waitcnt lgkmcnt(7)
    v_mfma_f32_32x32x16_bf16 v[144:159], v[236:239], v[48:51], v[144:159]
    ds_read_b128 v[56:59], v16 offset:40960
    ds_read_b64_tr_b16 v[224:225], v18 offset:45056
    ds_read_b64_tr_b16 v[226:227], v18 offset:45568
    v_mfma_f32_32x32x16_bf16 v[160:175], v[240:243], v[48:51], v[160:175]
    ds_read_b64_tr_b16 v[228:229], v19 offset:45056
    ds_read_b64_tr_b16 v[230:231], v19 offset:45568
    ds_read_b64_tr_b16 v[232:233], v20 offset:45056
    ds_read_b64_tr_b16 v[234:235], v20 offset:45568
    v_mfma_f32_32x32x16_bf16 v[176:191], v[244:247], v[48:51], v[176:191]
    s_add_u32 m0, s46, 131072
    s_mov_b32 s47, 688128
    buffer_load_dwordx4 v10, s[12:15], s47 offen lds
    s_add_u32 m0, s46, 139264
    s_mov_b32 s47, 688128
    buffer_load_dwordx4 v11, s[16:19], s47 offen lds
    s_waitcnt lgkmcnt(7)
    v_mfma_f32_32x32x16_bf16 v[144:159], v[192:195], v[52:55], v[144:159]
    ds_read_b128 v[60:63], v17 offset:40960
    ds_read_b64_tr_b16 v[236:237], v18 offset:47104
    ds_read_b64_tr_b16 v[238:239], v18 offset:47616
    v_mfma_f32_32x32x16_bf16 v[160:175], v[196:199], v[52:55], v[160:175]
    ds_read_b64_tr_b16 v[240:241], v19 offset:47104
    ds_read_b64_tr_b16 v[242:243], v19 offset:47616
    ds_read_b64_tr_b16 v[244:245], v20 offset:47104
    ds_read_b64_tr_b16 v[246:247], v20 offset:47616
    v_mfma_f32_32x32x16_bf16 v[176:191], v[200:203], v[52:55], v[176:191]
    s_add_u32 m0, s45, 0
    s_mov_b32 s47, 512
    buffer_load_dwordx4 v7, s[4:7], s47 offen lds
    s_add_u32 m0, s45, 1024
    s_mov_b32 s47, 512
    buffer_load_dwordx4 v8, s[4:7], s47 offen lds
    s_waitcnt vmcnt(7) lgkmcnt(0)
    s_barrier
    v_mfma_f32_32x32x16_bf16 v[144:159], v[224:227], v[56:59], v[144:159]
    v_add_u32 v14, 81920, v14
    v_add_u32 v15, 81920, v15
    v_add_u32 v16, 81920, v16
    v_add_u32 v17, 81920, v17
    v_add_u32 v18, 81920, v18
    v_add_u32 v19, 81920, v19
    v_add_u32 v20, 81920, v20
    ds_read_b128 v[64:67], v14 offset:0
    ds_read_b64_tr_b16 v[192:193], v18 offset:0
    ds_read_b64_tr_b16 v[194:195], v18 offset:512
    v_mfma_f32_32x32x16_bf16 v[160:175], v[228:231], v[56:59], v[160:175]
    ds_read_b64_tr_b16 v[196:197], v19 offset:0
    ds_read_b64_tr_b16 v[198:199], v19 offset:512
    ds_read_b64_tr_b16 v[200:201], v20 offset:0
    ds_read_b64_tr_b16 v[202:203], v20 offset:512
    v_mfma_f32_32x32x16_bf16 v[176:191], v[232:235], v[56:59], v[176:191]
    s_add_u32 m0, s46, 0
    s_mov_b32 s47, 688128
    buffer_load_dwordx4 v9, s[8:11], s47 offen lds
    s_add_u32 m0, s46, 8192
    s_mov_b32 s47, 917504
    buffer_load_dwordx4 v10, s[12:15], s47 offen lds
    s_waitcnt lgkmcnt(7)
    v_mfma_f32_32x32x16_bf16 v[144:159], v[236:239], v[60:63], v[144:159]
    ds_read_b128 v[68:71], v15 offset:0
    ds_read_b64_tr_b16 v[224:225], v18 offset:2048
    ds_read_b64_tr_b16 v[226:227], v18 offset:2560
    v_mfma_f32_32x32x16_bf16 v[160:175], v[240:243], v[60:63], v[160:175]
    ds_read_b64_tr_b16 v[228:229], v19 offset:2048
    ds_read_b64_tr_b16 v[230:231], v19 offset:2560
    ds_read_b64_tr_b16 v[232:233], v20 offset:2048
    ds_read_b64_tr_b16 v[234:235], v20 offset:2560
    v_mfma_f32_32x32x16_bf16 v[176:191], v[244:247], v[60:63], v[176:191]
    s_add_u32 m0, s46, 16384
    s_mov_b32 s47, 917504
    buffer_load_dwordx4 v11, s[16:19], s47 offen lds
    s_add_u32 m0, s45, 40960
    s_mov_b32 s47, 640
    buffer_load_dwordx4 v7, s[4:7], s47 offen lds
    s_waitcnt lgkmcnt(7)
    v_mfma_f32_32x32x16_bf16 v[144:159], v[192:195], v[64:67], v[144:159]
    ds_read_b128 v[72:75], v16 offset:0
    ds_read_b64_tr_b16 v[236:237], v18 offset:4096
    ds_read_b64_tr_b16 v[238:239], v18 offset:4608
    v_mfma_f32_32x32x16_bf16 v[160:175], v[196:199], v[64:67], v[160:175]
    ds_read_b64_tr_b16 v[240:241], v19 offset:4096
    ds_read_b64_tr_b16 v[242:243], v19 offset:4608
    ds_read_b64_tr_b16 v[244:245], v20 offset:4096
    ds_read_b64_tr_b16 v[246:247], v20 offset:4608
    v_mfma_f32_32x32x16_bf16 v[176:191], v[200:203], v[64:67], v[176:191]
    s_add_u32 m0, s45, 41984
    s_mov_b32 s47, 640
    buffer_load_dwordx4 v8, s[4:7], s47 offen lds
    s_waitcnt lgkmcnt(7)
    v_mfma_f32_32x32x16_bf16 v[144:159], v[224:227], v[68:71], v[144:159]
    ds_read_b128 v[76:79], v17 offset:0
    ds_read_b64_tr_b16 v[192:193], v18 offset:6144
    ds_read_b64_tr_b16 v[194:195], v18 offset:6656
    v_mfma_f32_32x32x16_bf16 v[160:175], v[228:231], v[68:71], v[160:175]
    ds_read_b64_tr_b16 v[196:197], v19 offset:6144
    ds_read_b64_tr_b16 v[198:199], v19 offset:6656
    ds_read_b64_tr_b16 v[200:201], v20 offset:6144
    ds_read_b64_tr_b16 v[202:203], v20 offset:6656
    v_mfma_f32_32x32x16_bf16 v[176:191], v[232:235], v[68:71], v[176:191]
    s_add_u32 m0, s46, 40960
    s_mov_b32 s47, 860160
    buffer_load_dwordx4 v9, s[8:11], s47 offen lds
    s_waitcnt vmcnt(8) lgkmcnt(0)
    s_barrier
    v_mfma_f32_32x32x16_bf16 v[144:159], v[236:239], v[72:75], v[144:159]
    ds_read_b128 v[80:83], v14 offset:40960
    ds_read_b64_tr_b16 v[224:225], v18 offset:40960
    ds_read_b64_tr_b16 v[226:227], v18 offset:41472
    v_mfma_f32_32x32x16_bf16 v[160:175], v[240:243], v[72:75], v[160:175]
    ds_read_b64_tr_b16 v[228:229], v19 offset:40960
    ds_read_b64_tr_b16 v[230:231], v19 offset:41472
    ds_read_b64_tr_b16 v[232:233], v20 offset:40960
    ds_read_b64_tr_b16 v[234:235], v20 offset:41472
    v_mfma_f32_32x32x16_bf16 v[176:191], v[244:247], v[72:75], v[176:191]
    s_add_u32 m0, s46, 49152
    s_mov_b32 s47, 1146880
    buffer_load_dwordx4 v10, s[12:15], s47 offen lds
    s_add_u32 m0, s46, 57344
    s_mov_b32 s47, 1146880
    buffer_load_dwordx4 v11, s[16:19], s47 offen lds
    s_waitcnt lgkmcnt(7)
    v_mfma_f32_32x32x16_bf16 v[144:159], v[192:195], v[76:79], v[144:159]
    ds_read_b128 v[84:87], v15 offset:40960
    ds_read_b64_tr_b16 v[236:237], v18 offset:43008
    ds_read_b64_tr_b16 v[238:239], v18 offset:43520
    v_mfma_f32_32x32x16_bf16 v[160:175], v[196:199], v[76:79], v[160:175]
    ds_read_b64_tr_b16 v[240:241], v19 offset:43008
    ds_read_b64_tr_b16 v[242:243], v19 offset:43520
    ds_read_b64_tr_b16 v[244:245], v20 offset:43008
    ds_read_b64_tr_b16 v[246:247], v20 offset:43520
    v_mfma_f32_32x32x16_bf16 v[176:191], v[200:203], v[76:79], v[176:191]
    s_add_u32 m0, s45, 81920
    s_mov_b32 s47, 768
    buffer_load_dwordx4 v7, s[4:7], s47 offen lds
    s_add_u32 m0, s45, 82944
    s_mov_b32 s47, 768
    buffer_load_dwordx4 v8, s[4:7], s47 offen lds
    s_waitcnt lgkmcnt(7)
    v_mfma_f32_32x32x16_bf16 v[144:159], v[224:227], v[80:83], v[144:159]
    ds_read_b128 v[88:91], v16 offset:40960
    ds_read_b64_tr_b16 v[192:193], v18 offset:45056
    ds_read_b64_tr_b16 v[194:195], v18 offset:45568
    v_mfma_f32_32x32x16_bf16 v[160:175], v[228:231], v[80:83], v[160:175]
    ds_read_b64_tr_b16 v[196:197], v19 offset:45056
    ds_read_b64_tr_b16 v[198:199], v19 offset:45568
    ds_read_b64_tr_b16 v[200:201], v20 offset:45056
    ds_read_b64_tr_b16 v[202:203], v20 offset:45568
    v_mfma_f32_32x32x16_bf16 v[176:191], v[232:235], v[80:83], v[176:191]
    s_add_u32 m0, s46, 81920
    s_mov_b32 s47, 1032192
    buffer_load_dwordx4 v9, s[8:11], s47 offen lds
    s_waitcnt lgkmcnt(7)
    v_mfma_f32_32x32x16_bf16 v[144:159], v[236:239], v[84:87], v[144:159]
    ds_read_b128 v[92:95], v17 offset:40960
    ds_read_b64_tr_b16 v[224:225], v18 offset:47104
    ds_read_b64_tr_b16 v[226:227], v18 offset:47616
    v_mfma_f32_32x32x16_bf16 v[160:175], v[240:243], v[84:87], v[160:175]
    ds_read_b64_tr_b16 v[228:229], v19 offset:47104
    ds_read_b64_tr_b16 v[230:231], v19 offset:47616
    ds_read_b64_tr_b16 v[232:233], v20 offset:47104
    ds_read_b64_tr_b16 v[234:235], v20 offset:47616
    v_mfma_f32_32x32x16_bf16 v[176:191], v[244:247], v[84:87], v[176:191]
    s_add_u32 m0, s46, 90112
    s_mov_b32 s47, 1376256
    buffer_load_dwordx4 v10, s[12:15], s47 offen lds
    s_waitcnt vmcnt(9) lgkmcnt(0)
    s_barrier
    v_mfma_f32_32x32x16_bf16 v[144:159], v[192:195], v[88:91], v[144:159]
    v_subrev_u32 v14, 81920, v14
    v_subrev_u32 v15, 81920, v15
    v_subrev_u32 v16, 81920, v16
    v_subrev_u32 v17, 81920, v17
    v_subrev_u32 v18, 81920, v18
    v_subrev_u32 v19, 81920, v19
    v_subrev_u32 v20, 81920, v20
    ds_read_b128 v[96:99], v14 offset:0
    ds_read_b64_tr_b16 v[236:237], v18 offset:0
    ds_read_b64_tr_b16 v[238:239], v18 offset:512
    v_mfma_f32_32x32x16_bf16 v[160:175], v[196:199], v[88:91], v[160:175]
    ds_read_b64_tr_b16 v[240:241], v19 offset:0
    ds_read_b64_tr_b16 v[242:243], v19 offset:512
    ds_read_b64_tr_b16 v[244:245], v20 offset:0
    ds_read_b64_tr_b16 v[246:247], v20 offset:512
    v_mfma_f32_32x32x16_bf16 v[176:191], v[200:203], v[88:91], v[176:191]
    s_add_u32 m0, s46, 98304
    s_mov_b32 s47, 1376256
    buffer_load_dwordx4 v11, s[16:19], s47 offen lds
    v_mov_b32 v13, 0
    buffer_load_dword v13, v13, s[32:35], 0 offen sc1
    s_waitcnt lgkmcnt(7)
    v_mfma_f32_32x32x16_bf16 v[144:159], v[224:227], v[92:95], v[144:159]
    ds_read_b128 v[100:103], v15 offset:0
    ds_read_b64_tr_b16 v[192:193], v18 offset:2048
    ds_read_b64_tr_b16 v[194:195], v18 offset:2560
    v_mfma_f32_32x32x16_bf16 v[160:175], v[228:231], v[92:95], v[160:175]
    ds_read_b64_tr_b16 v[196:197], v19 offset:2048
    ds_read_b64_tr_b16 v[198:199], v19 offset:2560
    ds_read_b64_tr_b16 v[200:201], v20 offset:2048
    ds_read_b64_tr_b16 v[202:203], v20 offset:2560
    v_mfma_f32_32x32x16_bf16 v[176:191], v[232:235], v[92:95], v[176:191]
    s_add_u32 m0, s46, 106496
    s_mov_b32 s47, 128
    buffer_load_dwordx4 v10, s[12:15], s47 offen lds
    s_waitcnt lgkmcnt(7)
    v_mfma_f32_32x32x16_bf16 v[144:159], v[236:239], v[96:99], v[144:159]
    ds_read_b128 v[104:107], v16 offset:0
    ds_read_b64_tr_b16 v[224:225], v18 offset:4096
    ds_read_b64_tr_b16 v[226:227], v18 offset:4608
    v_mfma_f32_32x32x16_bf16 v[160:175], v[240:243], v[96:99], v[160:175]
    ds_read_b64_tr_b16 v[228:229], v19 offset:4096
    ds_read_b64_tr_b16 v[230:231], v19 offset:4608
    ds_read_b64_tr_b16 v[232:233], v20 offset:4096
    ds_read_b64_tr_b16 v[234:235], v20 offset:4608
    v_mfma_f32_32x32x16_bf16 v[176:191], v[244:247], v[96:99], v[176:191]
    s_lshl_b32 s70, s61, 1
    s_and_b32 s44, s62, 1
    s_add_u32 s70, s70, s44
    s_lshr_b32 s71, s62, 1
    s_lshl_b32 s41, s61, 2
    s_and_b32 s44, s62, 3
    s_add_u32 s41, s41, s44
    s_add_u32 m0, s46, 114688
    s_mov_b32 s47, 128
    buffer_load_dwordx4 v11, s[16:19], s47 offen lds
    s_waitcnt lgkmcnt(7)
    v_mfma_f32_32x32x16_bf16 v[144:159], v[192:195], v[100:103], v[144:159]
    ds_read_b128 v[108:111], v17 offset:0
    ds_read_b64_tr_b16 v[236:237], v18 offset:6144
    ds_read_b64_tr_b16 v[238:239], v18 offset:6656
    v_mfma_f32_32x32x16_bf16 v[160:175], v[196:199], v[100:103], v[160:175]
    ds_read_b64_tr_b16 v[240:241], v19 offset:6144
    ds_read_b64_tr_b16 v[242:243], v19 offset:6656
    ds_read_b64_tr_b16 v[244:245], v20 offset:6144
    ds_read_b64_tr_b16 v[246:247], v20 offset:6656
    v_mfma_f32_32x32x16_bf16 v[176:191], v[200:203], v[100:103], v[176:191]
    s_lshr_b32 s3, s62, 2
    s_mul_i32 s57, s70, 7
    s_lshr_b32 s57, s57, 1
    s_lshl_b32 s56, s70, 12
    s_add_u32 s56, s56, 16842752
    s_lshr_b32 s43, s71, 2
    s_lshl_b32 s43, s43, 7
    s_add_u32 m0, s46, 122880
    s_mov_b32 s47, 229504
    buffer_load_dwordx4 v10, s[12:15], s47 offen lds
    s_waitcnt vmcnt(9) lgkmcnt(0)
    s_barrier
    v_mfma_f32_32x32x16_bf16 v[144:159], v[224:227], v[104:107], v[144:159]
    ds_read_b128 v[112:115], v14 offset:40960
    ds_read_b64_tr_b16 v[192:193], v18 offset:40960
    ds_read_b64_tr_b16 v[194:195], v18 offset:41472
    v_mfma_f32_32x32x16_bf16 v[160:175], v[228:231], v[104:107], v[160:175]
    ds_read_b64_tr_b16 v[196:197], v19 offset:40960
    ds_read_b64_tr_b16 v[198:199], v19 offset:41472
    ds_read_b64_tr_b16 v[200:201], v20 offset:40960
    ds_read_b64_tr_b16 v[202:203], v20 offset:41472
    v_mfma_f32_32x32x16_bf16 v[176:191], v[232:235], v[104:107], v[176:191]
    s_and_b32 s44, s71, 3
    s_lshl_b32 s44, s44, 2
    s_add_u32 s43, s43, s44
    s_add_u32 s43, s43, 2048
    v_lshrrev_b32 v26, 2, v1
    v_and_b32 v27, 3, v1
    v_lshlrev_b32 v27, 2, v27
    s_add_u32 m0, s46, 131072
    s_mov_b32 s47, 229504
    buffer_load_dwordx4 v11, s[16:19], s47 offen lds
    s_add_u32 m0, s46, 4294950912
    s_mov_b32 s47, 458880
    buffer_load_dwordx4 v10, s[12:15], s47 offen lds
    s_waitcnt lgkmcnt(7)
    v_mfma_f32_32x32x16_bf16 v[144:159], v[236:239], v[108:111], v[144:159]
    ds_read_b128 v[116:119], v15 offset:40960
    ds_read_b64_tr_b16 v[224:225], v18 offset:43008
    ds_read_b64_tr_b16 v[226:227], v18 offset:43520
    v_mfma_f32_32x32x16_bf16 v[160:175], v[240:243], v[108:111], v[160:175]
    ds_read_b64_tr_b16 v[228:229], v19 offset:43008
    ds_read_b64_tr_b16 v[230:231], v19 offset:43520
    ds_read_b64_tr_b16 v[232:233], v20 offset:43008
    ds_read_b64_tr_b16 v[234:235], v20 offset:43520
    v_mfma_f32_32x32x16_bf16 v[176:191], v[244:247], v[108:111], v[176:191]
    v_lshl_add_u32 v7, v26, 7, v27
    v_and_b32 v26, 1, v1
    v_lshl_add_u32 v8, v26, 9, s43
    v_and_b32 v26, 15, v1
    v_lshrrev_b32 v27, 4, v1
    v_lshlrev_b32 v29, 12, v26
    v_lshl_add_u32 v29, v27, 9, v29
    s_add_u32 m0, s46, 4294959104
    s_mov_b32 s47, 458880
    buffer_load_dwordx4 v11, s[16:19], s47 offen lds
    s_waitcnt lgkmcnt(7)
    v_mfma_f32_32x32x16_bf16 v[144:159], v[192:195], v[112:115], v[144:159]
    ds_read_b128 v[120:123], v16 offset:40960
    ds_read_b64_tr_b16 v[236:237], v18 offset:45056
    ds_read_b64_tr_b16 v[238:239], v18 offset:45568
    v_mfma_f32_32x32x16_bf16 v[160:175], v[196:199], v[112:115], v[160:175]
    ds_read_b64_tr_b16 v[240:241], v19 offset:45056
    ds_read_b64_tr_b16 v[242:243], v19 offset:45568
    ds_read_b64_tr_b16 v[244:245], v20 offset:45056
    ds_read_b64_tr_b16 v[246:247], v20 offset:45568
    v_mfma_f32_32x32x16_bf16 v[176:191], v[200:203], v[112:115], v[176:191]
    s_lshr_b32 s43, s36, 2
    s_lshl_b32 s43, s43, 7
    s_and_b32 s44, s36, 3
    s_lshl_b32 s44, s44, 2
    s_add_u32 s43, s43, s44
    s_add_u32 s44, s37, 1
    s_lshr_b32 s44, s44, 3
    s_add_u32 m0, s46, 0
    s_mov_b32 s47, 688256
    buffer_load_dwordx4 v10, s[12:15], s47 offen lds
    s_waitcnt lgkmcnt(7)
    v_mfma_f32_32x32x16_bf16 v[144:159], v[224:227], v[116:119], v[144:159]
    ds_read_b128 v[124:127], v17 offset:40960
    ds_read_b64_tr_b16 v[192:193], v18 offset:47104
    ds_read_b64_tr_b16 v[194:195], v18 offset:47616
    v_mfma_f32_32x32x16_bf16 v[160:175], v[228:231], v[116:119], v[160:175]
    ds_read_b64_tr_b16 v[196:197], v19 offset:47104
    ds_read_b64_tr_b16 v[198:199], v19 offset:47616
    ds_read_b64_tr_b16 v[200:201], v20 offset:47104
    ds_read_b64_tr_b16 v[202:203], v20 offset:47616
    v_mfma_f32_32x32x16_bf16 v[176:191], v[232:235], v[116:119], v[176:191]
    v_mul_u32_u24 v28, 7, v26
    v_lshrrev_b32 v28, 1, v28
    v_mad_u32_u24 v28, v27, 3, v28
    v_lshrrev_b32 v28, 3, v28
    v_lshrrev_b32 v27, 1, v27
    v_lshl_add_u32 v28, v27, 6, v28
    v_mad_u32_u24 v28, s44, 7, v28
    s_add_u32 m0, s46, 8192
    s_mov_b32 s47, 688256
    buffer_load_dwordx4 v11, s[16:19], s47 offen lds
    s_waitcnt vmcnt(9) lgkmcnt(0)
    s_barrier
    v_mfma_f32_32x32x16_bf16 v[144:159], v[236:239], v[120:123], v[144:159]
    v_add_u32 v14, 81920, v14
    v_add_u32 v15, 81920, v15
    v_add_u32 v16, 81920, v16
    v_add_u32 v17, 81920, v17
    v_add_u32 v18, 81920, v18
    v_add_u32 v19, 81920, v19
    v_add_u32 v20, 81920, v20
    ds_read_b128 v[128:131], v14 offset:0
    ds_read_b64_tr_b16 v[224:225], v18 offset:0
    ds_read_b64_tr_b16 v[226:227], v18 offset:512
    v_mfma_f32_32x32x16_bf16 v[160:175], v[240:243], v[120:123], v[160:175]
    ds_read_b64_tr_b16 v[228:229], v19 offset:0
    ds_read_b64_tr_b16 v[230:231], v19 offset:512
    ds_read_b64_tr_b16 v[232:233], v20 offset:0
    ds_read_b64_tr_b16 v[234:235], v20 offset:512
    v_mfma_f32_32x32x16_bf16 v[176:191], v[244:247], v[120:123], v[176:191]
    v_cmp_eq_u32 vcc, s37, v28
    s_lshl_b32 s44, s44, 11
    s_sub_u32 s43, s43, s44
    s_add_u32 s43, s43, 2048
    v_add_u32 v29, s43, v29
    v_mov_b32 v26, 1073741824
    v_cndmask_b32 v22, v26, v29, vcc
    s_add_u32 m0, s46, 24576
    s_mov_b32 s47, 917632
    buffer_load_dwordx4 v10, s[12:15], s47 offen lds
    s_waitcnt lgkmcnt(7)
    v_mfma_f32_32x32x16_bf16 v[144:159], v[192:195], v[124:127], v[144:159]
    ds_read_b128 v[132:135], v15 offset:0
    ds_read_b64_tr_b16 v[236:237], v18 offset:2048
    ds_read_b64_tr_b16 v[238:239], v18 offset:2560
    v_mfma_f32_32x32x16_bf16 v[160:175], v[196:199], v[124:127], v[160:175]
    ds_read_b64_tr_b16 v[240:241], v19 offset:2048
    ds_read_b64_tr_b16 v[242:243], v19 offset:2560
    ds_read_b64_tr_b16 v[244:245], v20 offset:2048
    ds_read_b64_tr_b16 v[246:247], v20 offset:2560
    v_mfma_f32_32x32x16_bf16 v[176:191], v[200:203], v[124:127], v[176:191]
    v_cmp_eq_u32 vcc, 0, v1
    s_lshr_b32 s55, s49, 1
    s_lshl_b32 s55, s55, 10
    v_cndmask_b32 v12, v26, v1, vcc
    s_lshr_b32 s43, s37, 1
    s_lshl_b32 s43, s43, 7
    s_add_u32 s55, s55, s43
    s_add_u32 m0, s46, 32768
    s_mov_b32 s47, 917632
    buffer_load_dwordx4 v11, s[16:19], s47 offen lds
    s_waitcnt lgkmcnt(7)
    v_mfma_f32_32x32x16_bf16 v[144:159], v[224:227], v[128:131], v[144:159]
    ds_read_b128 v[136:139], v16 offset:0
    ds_read_b64_tr_b16 v[192:193], v18 offset:4096
    ds_read_b64_tr_b16 v[194:195], v18 offset:4608
    v_mfma_f32_32x32x16_bf16 v[160:175], v[228:231], v[128:131], v[160:175]
    ds_read_b64_tr_b16 v[196:197], v19 offset:4096
    ds_read_b64_tr_b16 v[198:199], v19 offset:4608
    ds_read_b64_tr_b16 v[200:201], v20 offset:4096
    ds_read_b64_tr_b16 v[202:203], v20 offset:4608
    v_mfma_f32_32x32x16_bf16 v[176:191], v[232:235], v[128:131], v[176:191]
    s_and_b32 s43, s37, 1
    s_lshl_b32 s43, s43, 3
    s_add_u32 s55, s55, s43
    s_and_b32 s43, s39, 1
    s_lshl_b32 s43, s43, 2
    s_add_u32 s55, s55, s43
    s_add_u32 s55, s55, 16941056
    s_add_u32 m0, s46, 40960
    s_mov_b32 s47, 1147008
    buffer_load_dwordx4 v10, s[12:15], s47 offen lds
    s_waitcnt lgkmcnt(7)
    v_mfma_f32_32x32x16_bf16 v[144:159], v[236:239], v[132:135], v[144:159]
    ds_read_b128 v[140:143], v17 offset:0
    ds_read_b64_tr_b16 v[224:225], v18 offset:6144
    ds_read_b64_tr_b16 v[226:227], v18 offset:6656
    v_mfma_f32_32x32x16_bf16 v[160:175], v[240:243], v[132:135], v[160:175]
    ds_read_b64_tr_b16 v[228:229], v19 offset:6144
    ds_read_b64_tr_b16 v[230:231], v19 offset:6656
    ds_read_b64_tr_b16 v[232:233], v20 offset:6144
    ds_read_b64_tr_b16 v[234:235], v20 offset:6656
    v_mfma_f32_32x32x16_bf16 v[176:191], v[244:247], v[132:135], v[176:191]
    s_lshl_b32 s65, s36, 9
    s_lshr_b32 s43, s37, 2
    s_lshl_b32 s43, s43, 7
    s_add_u32 s65, s65, s43
    s_and_b32 s43, s37, 3
    s_lshl_b32 s43, s43, 2
    s_add_u32 s65, s65, s43
    s_add_u32 m0, s46, 49152
    s_mov_b32 s47, 1147008
    buffer_load_dwordx4 v11, s[16:19], s47 offen lds
    s_waitcnt vmcnt(4) lgkmcnt(0)
    v_readfirstlane_b32 s59, v13
    v_lshlrev_b32 v3, 2, v1
    v_add_u32 v3, 155648, v3
    v_mov_b32 v4, 0
    s_cmp_lg_u32 s59, 0
    s_cbranch_scc1 k1_nonce_ok_f
k1_nonce_spin_f:
    buffer_load_dword v13, v4, s[32:35], 0 offen sc1
    s_waitcnt vmcnt(0)
    v_readfirstlane_b32 s59, v13
    s_sleep 4
    s_cmp_eq_u32 s59, 0
    s_cbranch_scc1 k1_nonce_spin_f
k1_nonce_ok_f:
    ds_write_b32 v3, v4
    s_barrier
    v_mfma_f32_32x32x16_bf16 v[144:159], v[192:195], v[136:139], v[144:159]
    v_subrev_u32 v19, 8192, v19
    v_subrev_u32 v20, 8192, v20
    ds_read_b64_tr_b16 v[248:249], v19 offset:24576
    ds_read_b64_tr_b16 v[250:251], v19 offset:25088
    v_mfma_f32_32x32x16_bf16 v[160:175], v[196:199], v[136:139], v[160:175]
    ds_read_b64_tr_b16 v[252:253], v20 offset:24576
    ds_read_b64_tr_b16 v[254:255], v20 offset:25088
    v_mfma_f32_32x32x16_bf16 v[176:191], v[200:203], v[136:139], v[176:191]
    s_add_u32 s65, s65, 16908288
    s_lshl_b32 s54, s3, 7
    s_mul_i32 s53, s39, 14336
    s_add_u32 s53, s53, s54
    s_lshl_b32 s54, s39, 11
    s_add_u32 m0, s46, 65536
    s_mov_b32 s47, 1376384
    buffer_load_dwordx4 v10, s[12:15], s47 offen lds
    s_waitcnt lgkmcnt(4)
    v_mfma_f32_32x32x16_bf16 v[144:159], v[224:227], v[140:143], v[144:159]
    ds_read_b64_tr_b16 v[240:241], v19 offset:26624
    ds_read_b64_tr_b16 v[242:243], v19 offset:27136
    v_mfma_f32_32x32x16_bf16 v[160:175], v[228:231], v[140:143], v[160:175]
    ds_read_b64_tr_b16 v[244:245], v20 offset:26624
    ds_read_b64_tr_b16 v[246:247], v20 offset:27136
    v_mfma_f32_32x32x16_bf16 v[176:191], v[232:235], v[140:143], v[176:191]
    s_add_u32 m0, s46, 73728
    s_mov_b32 s47, 1376384
    buffer_load_dwordx4 v11, s[16:19], s47 offen lds
    ds_read_b64_tr_b16 v[232:233], v19 offset:28672
    ds_read_b64_tr_b16 v[234:235], v19 offset:29184
    ds_read_b64_tr_b16 v[236:237], v20 offset:28672
    ds_read_b64_tr_b16 v[238:239], v20 offset:29184
    s_waitcnt lgkmcnt(8)
    v_mfma_f32_32x32x16_bf16 v[192:207], v[248:251], v[32:35], 0
    ds_read_b64_tr_b16 v[224:225], v19 offset:30720
    ds_read_b64_tr_b16 v[226:227], v19 offset:31232
    v_mfma_f32_32x32x16_bf16 v[208:223], v[252:255], v[32:35], 0
    ds_read_b64_tr_b16 v[228:229], v20 offset:30720
    ds_read_b64_tr_b16 v[230:231], v20 offset:31232
    s_waitcnt lgkmcnt(8)
    v_mfma_f32_32x32x16_bf16 v[192:207], v[240:243], v[36:39], v[192:207]
    v_add_u32 v19, 32768, v19
    v_add_u32 v20, 32768, v20
    ds_read_b64_tr_b16 v[248:249], v19 offset:8192
    ds_read_b64_tr_b16 v[250:251], v19 offset:8704
    s_nop 3
    v_mul_f32 v144, s48, v144
    v_mul_f32 v145, s48, v145
    v_cvt_pk_bf16_f32 v144, v144, v145
    v_mul_f32 v146, s48, v146
    v_mfma_f32_32x32x16_bf16 v[208:223], v[244:247], v[36:39], v[208:223]
    ds_read_b64_tr_b16 v[252:253], v20 offset:8192
    ds_read_b64_tr_b16 v[254:255], v20 offset:8704
    v_mul_f32 v147, s48, v147
    v_cvt_pk_bf16_f32 v145, v146, v147
    v_mul_f32 v148, s48, v148
    v_mul_f32 v149, s48, v149
    v_cvt_pk_bf16_f32 v146, v148, v149
    s_waitcnt lgkmcnt(8)
    v_mfma_f32_32x32x16_bf16 v[192:207], v[232:235], v[40:43], v[192:207]
    ds_read_b64_tr_b16 v[240:241], v19 offset:10240
    ds_read_b64_tr_b16 v[242:243], v19 offset:10752
    v_mul_f32 v150, s48, v150
    v_mul_f32 v151, s48, v151
    v_cvt_pk_bf16_f32 v147, v150, v151
    v_mul_f32 v152, s48, v152
    v_mul_f32 v153, s48, v153
    v_mfma_f32_32x32x16_bf16 v[208:223], v[236:239], v[40:43], v[208:223]
    ds_read_b64_tr_b16 v[244:245], v20 offset:10240
    ds_read_b64_tr_b16 v[246:247], v20 offset:10752
    v_cvt_pk_bf16_f32 v148, v152, v153
    v_mul_f32 v154, s48, v154
    v_mul_f32 v155, s48, v155
    v_cvt_pk_bf16_f32 v149, v154, v155
    v_mul_f32 v156, s48, v156
    s_waitcnt lgkmcnt(8)
    v_mfma_f32_32x32x16_bf16 v[192:207], v[224:227], v[44:47], v[192:207]
    ds_read_b64_tr_b16 v[232:233], v19 offset:12288
    ds_read_b64_tr_b16 v[234:235], v19 offset:12800
    v_mul_f32 v157, s48, v157
    v_cvt_pk_bf16_f32 v150, v156, v157
    v_mul_f32 v158, s48, v158
    v_mul_f32 v159, s48, v159
    v_cvt_pk_bf16_f32 v151, v158, v159
    v_mfma_f32_32x32x16_bf16 v[208:223], v[228:231], v[44:47], v[208:223]
    ds_read_b64_tr_b16 v[236:237], v20 offset:12288
    ds_read_b64_tr_b16 v[238:239], v20 offset:12800
    s_nop 1
    v_permlane32_swap_b32 v144, v146
    v_permlane32_swap_b32 v145, v147
    buffer_store_dwordx4 v[144:147], v2, s[20:23], s52 offen offset:0 sc1
    v_permlane32_swap_b32 v148, v150
    s_waitcnt lgkmcnt(8)
    v_mfma_f32_32x32x16_bf16 v[192:207], v[248:251], v[48:51], v[192:207]
    ds_read_b64_tr_b16 v[224:225], v19 offset:14336
    ds_read_b64_tr_b16 v[226:227], v19 offset:14848
    v_permlane32_swap_b32 v149, v151
    buffer_store_dwordx4 v[148:151], v2, s[20:23], s52 offen offset:1024 sc1
    v_mfma_f32_32x32x16_bf16 v[208:223], v[252:255], v[48:51], v[208:223]
    ds_read_b64_tr_b16 v[228:229], v20 offset:14336
    ds_read_b64_tr_b16 v[230:231], v20 offset:14848
    v_mul_f32 v32, s60, v160
    v_mul_f32 v33, s60, v161
    v_mul_f32 v34, s60, v162
    v_mul_f32 v35, s60, v163
    s_waitcnt lgkmcnt(8)
    v_mfma_f32_32x32x16_bf16 v[192:207], v[240:243], v[52:55], v[192:207]
    v_subrev_u32 v19, 131072, v19
    v_subrev_u32 v20, 131072, v20
    ds_read_b64_tr_b16 v[248:249], v19 offset:0
    ds_read_b64_tr_b16 v[250:251], v19 offset:512
    v_mul_f32 v36, s60, v164
    v_mul_f32 v37, s60, v165
    v_mul_f32 v38, s60, v166
    v_mul_f32 v39, s60, v167
    v_mfma_f32_32x32x16_bf16 v[208:223], v[244:247], v[52:55], v[208:223]
    ds_read_b64_tr_b16 v[252:253], v20 offset:0
    ds_read_b64_tr_b16 v[254:255], v20 offset:512
    v_exp_f32 v32, v32
    v_exp_f32 v33, v33
    v_exp_f32 v34, v34
    v_exp_f32 v35, v35
    s_mul_i32 s45, s40, 7168
    s_add_u32 s45, s45, s53
    s_cmp_ge_u32 s62, 28
    s_cselect_b32 s45, 1073741824, s45
    s_lshl_b32 s58, s40, 10
    s_add_u32 s58, s58, s54
    s_add_u32 m0, s58, 98304
    s_add_u32 s42, s45, 0
    buffer_load_dwordx4 v31, s[28:31], s42 offen lds
    s_waitcnt lgkmcnt(8)
    v_mfma_f32_32x32x16_bf16 v[192:207], v[232:235], v[56:59], v[192:207]
    ds_read_b64_tr_b16 v[240:241], v19 offset:2048
    ds_read_b64_tr_b16 v[242:243], v19 offset:2560
    v_exp_f32 v36, v36
    v_exp_f32 v37, v37
    v_exp_f32 v38, v38
    v_exp_f32 v39, v39
    v_mfma_f32_32x32x16_bf16 v[208:223], v[236:239], v[56:59], v[208:223]
    ds_read_b64_tr_b16 v[244:245], v20 offset:2048
    ds_read_b64_tr_b16 v[246:247], v20 offset:2560
    v_add_f32 v32, 1.0, v32
    v_add_f32 v33, 1.0, v33
    v_add_f32 v34, 1.0, v34
    v_add_f32 v35, 1.0, v35
    s_add_u32 m0, s58, 106496
    s_add_u32 s42, s45, 114688
    buffer_load_dwordx4 v31, s[28:31], s42 offen lds
    s_waitcnt lgkmcnt(8)
    v_mfma_f32_32x32x16_bf16 v[192:207], v[224:227], v[60:63], v[192:207]
    ds_read_b64_tr_b16 v[232:233], v19 offset:4096
    ds_read_b64_tr_b16 v[234:235], v19 offset:4608
    v_add_f32 v36, 1.0, v36
    v_add_f32 v37, 1.0, v37
    v_add_f32 v38, 1.0, v38
    v_add_f32 v39, 1.0, v39
    v_mfma_f32_32x32x16_bf16 v[208:223], v[228:231], v[60:63], v[208:223]
    ds_read_b64_tr_b16 v[236:237], v20 offset:4096
    ds_read_b64_tr_b16 v[238:239], v20 offset:4608
    v_rcp_f32 v32, v32
    v_rcp_f32 v33, v33
    v_rcp_f32 v34, v34
    v_rcp_f32 v35, v35
    s_add_u32 m0, s58, 114688
    s_add_u32 s42, s45, 229376
    buffer_load_dwordx4 v31, s[28:31], s42 offen lds
    s_waitcnt lgkmcnt(8)
    v_mfma_f32_32x32x16_bf16 v[192:207], v[248:251], v[64:67], v[192:207]
    ds_read_b64_tr_b16 v[224:225], v19 offset:6144
    ds_read_b64_tr_b16 v[226:227], v19 offset:6656
    v_rcp_f32 v36, v36
    v_rcp_f32 v37, v37
    v_rcp_f32 v38, v38
    v_rcp_f32 v39, v39
    v_mfma_f32_32x32x16_bf16 v[208:223], v[252:255], v[64:67], v[208:223]
    ds_read_b64_tr_b16 v[228:229], v20 offset:6144
    ds_read_b64_tr_b16 v[230:231], v20 offset:6656
    v_mul_f32 v160, v160, v32
    v_mul_f32 v161, v161, v33
    v_mul_f32 v162, v162, v34
    v_mul_f32 v163, v163, v35
    s_waitcnt lgkmcnt(8)
    v_mfma_f32_32x32x16_bf16 v[192:207], v[240:243], v[68:71], v[192:207]
    ds_read_b64_tr_b16 v[248:249], v19 offset:16384
    ds_read_b64_tr_b16 v[250:251], v19 offset:16896
    v_mul_f32 v164, v164, v36
    v_mul_f32 v165, v165, v37
    v_mul_f32 v166, v166, v38
    v_mul_f32 v167, v167, v39
    v_mfma_f32_32x32x16_bf16 v[208:223], v[244:247], v[68:71], v[208:223]
    ds_read_b64_tr_b16 v[252:253], v20 offset:16384
    ds_read_b64_tr_b16 v[254:255], v20 offset:16896
    v_mul_f32 v168, v168, v160
    v_mul_f32 v169, v169, v161
    v_mul_f32 v170, v170, v162
    v_mul_f32 v171, v171, v163
    s_waitcnt lgkmcnt(8)
    v_mfma_f32_32x32x16_bf16 v[192:207], v[232:235], v[72:75], v[192:207]
    ds_read_b64_tr_b16 v[240:241], v19 offset:18432
    ds_read_b64_tr_b16 v[242:243], v19 offset:18944
    v_mul_f32 v172, v172, v164
    v_mul_f32 v173, v173, v165
    v_mul_f32 v174, v174, v166
    v_mul_f32 v175, v175, v167
    v_mfma_f32_32x32x16_bf16 v[208:223], v[236:239], v[72:75], v[208:223]
    ds_read_b64_tr_b16 v[244:245], v20 offset:18432
    ds_read_b64_tr_b16 v[246:247], v20 offset:18944
    v_cvt_pk_bf16_f32 v48, v168, v169
    v_cvt_pk_bf16_f32 v49, v170, v171
    v_cvt_pk_bf16_f32 v50, v172, v173
    v_cvt_pk_bf16_f32 v51, v174, v175
    s_waitcnt vmcnt(3)
    s_barrier
    s_cmp_lg_u32 s38, 7
    s_cbranch_scc1 k1_noflag_f
    s_mov_b32 s42, 16842752
    buffer_store_dword v13, v22, s[20:23], s42 offen sc1
k1_noflag_f:
    s_waitcnt lgkmcnt(8)
    v_mfma_f32_32x32x16_bf16 v[192:207], v[224:227], v[76:79], v[192:207]
    ds_read_b64_tr_b16 v[232:233], v19 offset:20480
    ds_read_b64_tr_b16 v[234:235], v19 offset:20992
    v_mul_f32 v40, s60, v176
    v_mul_f32 v41, s60, v177
    v_mul_f32 v42, s60, v178
    v_mul_f32 v43, s60, v179
    v_mfma_f32_32x32x16_bf16 v[208:223], v[228:231], v[76:79], v[208:223]
    ds_read_b64_tr_b16 v[236:237], v20 offset:20480
    ds_read_b64_tr_b16 v[238:239], v20 offset:20992
    v_mul_f32 v44, s60, v180
    v_mul_f32 v45, s60, v181
    v_mul_f32 v46, s60, v182
    v_mul_f32 v47, s60, v183
    s_add_u32 m0, s58, 122880
    s_add_u32 s42, s45, 344064
    buffer_load_dwordx4 v31, s[28:31], s42 offen lds
    s_waitcnt lgkmcnt(8)
    v_mfma_f32_32x32x16_bf16 v[192:207], v[248:251], v[80:83], v[192:207]
    ds_read_b64_tr_b16 v[224:225], v19 offset:22528
    ds_read_b64_tr_b16 v[226:227], v19 offset:23040
    v_exp_f32 v40, v40
    v_exp_f32 v41, v41
    v_exp_f32 v42, v42
    v_exp_f32 v43, v43
    v_mfma_f32_32x32x16_bf16 v[208:223], v[252:255], v[80:83], v[208:223]
    ds_read_b64_tr_b16 v[228:229], v20 offset:22528
    ds_read_b64_tr_b16 v[230:231], v20 offset:23040
    v_exp_f32 v44, v44
    v_exp_f32 v45, v45
    v_exp_f32 v46, v46
    v_exp_f32 v47, v47
    s_add_u32 m0, s58, 131072
    s_add_u32 s42, s45, 458752
    buffer_load_dwordx4 v31, s[28:31], s42 offen lds
    s_waitcnt lgkmcnt(8)
    v_mfma_f32_32x32x16_bf16 v[192:207], v[240:243], v[84:87], v[192:207]
    v_add_u32 v19, 32768, v19
    v_add_u32 v20, 32768, v20
    ds_read_b64_tr_b16 v[248:249], v19 offset:8192
    ds_read_b64_tr_b16 v[250:251], v19 offset:8704
    buffer_store_dwordx4 v[48:51], v2, s[20:23], s50 offen offset:0 sc1
    v_add_f32 v40, 1.0, v40
    v_add_f32 v41, 1.0, v41
    v_add_f32 v42, 1.0, v42
    v_mfma_f32_32x32x16_bf16 v[208:223], v[244:247], v[84:87], v[208:223]
    ds_read_b64_tr_b16 v[252:253], v20 offset:8192
    ds_read_b64_tr_b16 v[254:255], v20 offset:8704
    v_add_f32 v43, 1.0, v43
    v_add_f32 v44, 1.0, v44
    v_add_f32 v45, 1.0, v45
    v_add_f32 v46, 1.0, v46
    s_add_u32 m0, s58, 139264
    s_add_u32 s42, s45, 573440
    buffer_load_dwordx4 v31, s[28:31], s42 offen lds
    s_waitcnt lgkmcnt(8)
    v_mfma_f32_32x32x16_bf16 v[192:207], v[232:235], v[88:91], v[192:207]
    ds_read_b64_tr_b16 v[240:241], v19 offset:10240
    ds_read_b64_tr_b16 v[242:243], v19 offset:10752
    v_add_f32 v47, 1.0, v47
    v_rcp_f32 v40, v40
    v_rcp_f32 v41, v41
    v_rcp_f32 v42, v42
    v_mfma_f32_32x32x16_bf16 v[208:223], v[236:239], v[88:91], v[208:223]
    ds_read_b64_tr_b16 v[244:245], v20 offset:10240
    ds_read_b64_tr_b16 v[246:247], v20 offset:10752
    v_rcp_f32 v43, v43
    v_rcp_f32 v44, v44
    v_rcp_f32 v45, v45
    v_rcp_f32 v46, v46
    s_add_u32 m0, s58, 147456
    s_add_u32 s42, s45, 688128
    buffer_load_dwordx4 v31, s[28:31], s42 offen lds
    s_waitcnt lgkmcnt(8)
    v_mfma_f32_32x32x16_bf16 v[192:207], v[224:227], v[92:95], v[192:207]
    ds_read_b64_tr_b16 v[232:233], v19 offset:12288
    ds_read_b64_tr_b16 v[234:235], v19 offset:12800
    v_rcp_f32 v47, v47
    v_mul_f32 v176, v176, v40
    v_mul_f32 v177, v177, v41
    v_mul_f32 v178, v178, v42
    v_mfma_f32_32x32x16_bf16 v[208:223], v[228:231], v[92:95], v[208:223]
    ds_read_b64_tr_b16 v[236:237], v20 offset:12288
    ds_read_b64_tr_b16 v[238:239], v20 offset:12800
    v_mul_f32 v179, v179, v43
    v_mul_f32 v180, v180, v44
    v_mul_f32 v181, v181, v45
    v_mul_f32 v182, v182, v46
    s_waitcnt lgkmcnt(8)
    v_mfma_f32_32x32x16_bf16 v[192:207], v[248:251], v[96:99], v[192:207]
    ds_read_b64_tr_b16 v[224:225], v19 offset:14336
    ds_read_b64_tr_b16 v[226:227], v19 offset:14848
    v_mul_f32 v183, v183, v47
    v_mul_f32 v184, v184, v176
    v_mul_f32 v185, v185, v177
    v_mul_f32 v186, v186, v178
    v_mfma_f32_32x32x16_bf16 v[208:223], v[252:255], v[96:99], v[208:223]
    ds_read_b64_tr_b16 v[228:229], v20 offset:14336
    ds_read_b64_tr_b16 v[230:231], v20 offset:14848
    v_mul_f32 v187, v187, v179
    v_mul_f32 v188, v188, v180
    v_mul_f32 v189, v189, v181
    v_mul_f32 v190, v190, v182
    s_waitcnt lgkmcnt(8)
    v_mfma_f32_32x32x16_bf16 v[192:207], v[240:243], v[100:103], v[192:207]
    ds_read_b64_tr_b16 v[248:249], v19 offset:24576
    ds_read_b64_tr_b16 v[250:251], v19 offset:25088
    v_mul_f32 v191, v191, v183
    v_cvt_pk_bf16_f32 v52, v184, v185
    v_cvt_pk_bf16_f32 v53, v186, v187
    v_cvt_pk_bf16_f32 v54, v188, v189
    v_mfma_f32_32x32x16_bf16 v[208:223], v[244:247], v[100:103], v[208:223]
    ds_read_b64_tr_b16 v[252:253], v20 offset:24576
    ds_read_b64_tr_b16 v[254:255], v20 offset:25088
    v_cvt_pk_bf16_f32 v55, v190, v191
    buffer_store_dwordx4 v[52:55], v2, s[20:23], s50 offen offset:1024 sc1
    s_waitcnt lgkmcnt(8)
    v_mfma_f32_32x32x16_bf16 v[192:207], v[232:235], v[104:107], v[192:207]
    ds_read_b64_tr_b16 v[240:241], v19 offset:26624
    ds_read_b64_tr_b16 v[242:243], v19 offset:27136
    v_mfma_f32_32x32x16_bf16 v[208:223], v[236:239], v[104:107], v[208:223]
    ds_read_b64_tr_b16 v[244:245], v20 offset:26624
    ds_read_b64_tr_b16 v[246:247], v20 offset:27136
    s_waitcnt lgkmcnt(8)
    v_mfma_f32_32x32x16_bf16 v[192:207], v[224:227], v[108:111], v[192:207]
    ds_read_b64_tr_b16 v[232:233], v19 offset:28672
    ds_read_b64_tr_b16 v[234:235], v19 offset:29184
    v_mfma_f32_32x32x16_bf16 v[208:223], v[228:231], v[108:111], v[208:223]
    ds_read_b64_tr_b16 v[236:237], v20 offset:28672
    ds_read_b64_tr_b16 v[238:239], v20 offset:29184
    s_waitcnt lgkmcnt(8)
    v_mfma_f32_32x32x16_bf16 v[192:207], v[248:251], v[112:115], v[192:207]
    ds_read_b64_tr_b16 v[224:225], v19 offset:30720
    ds_read_b64_tr_b16 v[226:227], v19 offset:31232
    v_mfma_f32_32x32x16_bf16 v[208:223], v[252:255], v[112:115], v[208:223]
    ds_read_b64_tr_b16 v[228:229], v20 offset:30720
    ds_read_b64_tr_b16 v[230:231], v20 offset:31232
    s_waitcnt lgkmcnt(8)
    v_mfma_f32_32x32x16_bf16 v[192:207], v[240:243], v[116:119], v[192:207]
    v_add_u32 v19, 32768, v19
    v_add_u32 v20, 32768, v20
    ds_read_b64_tr_b16 v[248:249], v19 offset:16384
    ds_read_b64_tr_b16 v[250:251], v19 offset:16896
    v_mfma_f32_32x32x16_bf16 v[208:223], v[244:247], v[116:119], v[208:223]
    ds_read_b64_tr_b16 v[252:253], v20 offset:16384
    ds_read_b64_tr_b16 v[254:255], v20 offset:16896
    s_waitcnt lgkmcnt(8)
    v_mfma_f32_32x32x16_bf16 v[192:207], v[232:235], v[120:123], v[192:207]
    ds_read_b64_tr_b16 v[240:241], v19 offset:18432
    ds_read_b64_tr_b16 v[242:243], v19 offset:18944
    v_mfma_f32_32x32x16_bf16 v[208:223], v[236:239], v[120:123], v[208:223]
    ds_read_b64_tr_b16 v[244:245], v20 offset:18432
    ds_read_b64_tr_b16 v[246:247], v20 offset:18944
    s_waitcnt lgkmcnt(8)
    v_mfma_f32_32x32x16_bf16 v[192:207], v[224:227], v[124:127], v[192:207]
    ds_read_b64_tr_b16 v[232:233], v19 offset:20480
    ds_read_b64_tr_b16 v[234:235], v19 offset:20992
    v_mfma_f32_32x32x16_bf16 v[208:223], v[228:231], v[124:127], v[208:223]
    ds_read_b64_tr_b16 v[236:237], v20 offset:20480
    ds_read_b64_tr_b16 v[238:239], v20 offset:20992
    s_waitcnt lgkmcnt(8)
    v_mfma_f32_32x32x16_bf16 v[192:207], v[248:251], v[128:131], v[192:207]
    ds_read_b64_tr_b16 v[224:225], v19 offset:22528
    ds_read_b64_tr_b16 v[226:227], v19 offset:23040
    v_mfma_f32_32x32x16_bf16 v[208:223], v[252:255], v[128:131], v[208:223]
    ds_read_b64_tr_b16 v[228:229], v20 offset:22528
    ds_read_b64_tr_b16 v[230:231], v20 offset:23040
    s_waitcnt lgkmcnt(8)
    v_mfma_f32_32x32x16_bf16 v[192:207], v[240:243], v[132:135], v[192:207]
    v_mfma_f32_32x32x16_bf16 v[208:223], v[244:247], v[132:135], v[208:223]
    s_waitcnt lgkmcnt(4)
    v_mfma_f32_32x32x16_bf16 v[192:207], v[232:235], v[136:139], v[192:207]
    v_mfma_f32_32x32x16_bf16 v[208:223], v[236:239], v[136:139], v[208:223]
    s_waitcnt lgkmcnt(0)
    v_mfma_f32_32x32x16_bf16 v[192:207], v[224:227], v[140:143], v[192:207]
    v_mfma_f32_32x32x16_bf16 v[208:223], v[228:231], v[140:143], v[208:223]
    s_cmp_lg_u32 s38, 0
    s_cbranch_scc1 k1_nopoll
    buffer_load_dword v9, v7, s[20:23], s56 offen sc1
    buffer_load_dword v10, v8, s[20:23], s56 offen sc1
k1_nopoll:
    s_nop 7
    s_nop 3
    v_mul_f32 v64, s60, v192
    v_mul_f32 v65, s60, v193
    v_mul_f32 v66, s60, v194
    v_mul_f32 v67, s60, v195
    v_mul_f32 v68, s60, v196
    v_mul_f32 v69, s60, v197
    v_mul_f32 v70, s60, v198
    v_mul_f32 v71, s60, v199
    v_exp_f32 v64, v64
    v_exp_f32 v65, v65
    v_exp_f32 v66, v66
    v_exp_f32 v67, v67
    v_exp_f32 v68, v68
    v_exp_f32 v69, v69
    v_exp_f32 v70, v70
    v_exp_f32 v71, v71
    v_add_f32 v64, 1.0, v64
    v_add_f32 v65, 1.0, v65
    v_add_f32 v66, 1.0, v66
    v_add_f32 v67, 1.0, v67
    v_add_f32 v68, 1.0, v68
    v_add_f32 v69, 1.0, v69
    v_add_f32 v70, 1.0, v70
    v_add_f32 v71, 1.0, v71
    v_rcp_f32 v64, v64
    v_rcp_f32 v65, v65
    v_rcp_f32 v66, v66
    v_rcp_f32 v67, v67
    v_rcp_f32 v68, v68
    v_rcp_f32 v69, v69
    v_rcp_f32 v70, v70
    v_rcp_f32 v71, v71
    v_mul_f32 v192, v192, v64
    v_mul_f32 v193, v193, v65
    v_mul_f32 v194, v194, v66
    v_mul_f32 v195, v195, v67
    v_mul_f32 v196, v196, v68
    v_mul_f32 v197, v197, v69
    v_mul_f32 v198, v198, v70
    v_mul_f32 v199, v199, v71
    v_mul_f32 v200, v200, v192
    v_mul_f32 v201, v201, v193
    v_mul_f32 v202, v202, v194
    v_mul_f32 v203, v203, v195
    v_mul_f32 v204, v204, v196
    v_mul_f32 v205, v205, v197
    v_mul_f32 v206, v206, v198
    v_mul_f32 v207, v207, v199
    v_cvt_pk_bf16_f32 v240, v200, v201
    v_cvt_pk_bf16_f32 v241, v202, v203
    v_cvt_pk_bf16_f32 v242, v204, v205
    v_cvt_pk_bf16_f32 v243, v206, v207
    v_mov_b32 v3, 155680
    v_mov_b32 v4, 1
    s_waitcnt vmcnt(0)
    s_mov_b64 exec, 1
    ds_add_rtn_u32 v4, v3, v4
    s_mov_b64 exec, -1
    s_waitcnt lgkmcnt(0)
    v_readfirstlane_b32 s42, v4
    s_cmp_lg_u32 s42, 7
    s_cbranch_scc1 k1_nofa
    buffer_store_dword v13, v12, s[20:23], s65 offen sc1
k1_nofa:
    s_cmp_ge_u32 s38, 4
    s_cbranch_scc1 k1_epi
    s_cmp_lg_u32 s38, 0
    s_cbranch_scc1 k1_w123
    v_cmp_ne_u32 vcc, s59, v9
    v_cmp_ne_u32 s[16:17], s59, v10
    s_nop 0
    s_or_b32 s42, vcc_lo, s16
    s_cselect_b32 s42, 4, 5
    s_cmp_eq_u32 vcc_hi, 0
    s_cselect_b32 s43, 2, 0
    s_or_b32 s42, s42, s43
    v_mov_b32 v3, 155652
    v_mov_b32 v4, s42
    ds_write_b32 v3, v4
    s_bitcmp1_b32 s42, 0
    s_cbranch_scc1 k1_early
    buffer_load_dword v9, v7, s[20:23], s56 offen sc1
    buffer_load_dword v10, v8, s[20:23], s56 offen sc1
    s_branch k1_epi
k1_w123:
    v_mov_b32 v3, 155652
lw1:
    ds_read_b32 v4, v3
    s_waitcnt lgkmcnt(0)
    v_readfirstlane_b32 s42, v4
    s_cmp_lg_u32 s42, 0
    s_cbranch_scc1 lwd1
    s_sleep 1
    s_branch lw1
lwd1:
    s_bitcmp1_b32 s42, 0
    s_cbranch_scc0 k1_epi
k1_early:
    s_mov_b32 s58, s42
    s_lshl_b32 s43, s57, 9
    s_lshl_b32 s44, s71, 2
    s_add_u32 s44, s44, s39
    s_mul_i32 s42, s44, 28672
    s_add_u32 s42, s42, s43
    buffer_load_dwordx4 v[16:19], v2, s[20:23], s42 offen sc1
    buffer_load_dwordx4 v[20:23], v2, s[20:23], s42 offen offset:1024 sc1
    s_mul_i32 s46, s39, 458752
    s_add_u32 s45, s46, s43
    s_add_u32 s45, s45, 2097152
    s_mul_i32 s42, s70, 448
    s_add_u32 s46, s46, s42
    s_add_u32 s46, s46, 4194304
    s_and_b32 s47, s71, 15
    s_mov_b32 s30, 0x0fffffff
    s_mov_b32 s31, 0x0fffffff
    v_lshrrev_b32 v14, 5, v1
    v_mul_u32_u24 v14, 6656, v14
    v_add_u32 v14, v14, v2
    v_add_u32 v11, 14336, v14
    s_add_u32 s42, s47, 0
    s_and_b32 s42, s42, 15
    s_mul_i32 s48, s42, 28672
    s_add_u32 s48, s48, s45
    buffer_load_dwordx4 v[144:147], v2, s[20:23], s48 offen offset:0 sc1
    buffer_load_dwordx4 v[148:151], v2, s[20:23], s48 offen offset:1024 sc1
    s_bitcmp1_b32 s58, 1
    s_cbranch_scc1 k1_rp
    s_cmp_lg_u32 s38, 0
    s_cbranch_scc1 k1_rp
    buffer_load_dword v9, v7, s[20:23], s56 offen sc1
    buffer_load_dword v10, v8, s[20:23], s56 offen sc1
k1_rp:
    v_mul_f32 v72, s60, v208
    v_mov_b32 v152, 0x3f803f80
    v_mul_f32 v73, s60, v209
    v_mov_b32 v153, 0x3f803f80
    v_mul_f32 v74, s60, v210
    v_mov_b32 v154, 0x3f803f80
    v_mul_f32 v75, s60, v211
    v_mov_b32 v155, 0x3f803f80
    v_mul_f32 v76, s60, v212
    v_mov_b32 v156, 0x3f803f80
    v_mul_f32 v77, s60, v213
    v_mov_b32 v157, 0x3f803f80
    v_mul_f32 v78, s60, v214
    v_mov_b32 v158, 0x3f803f80
    v_mul_f32 v79, s60, v215
    v_mov_b32 v159, 0x3f803f80
    v_exp_f32 v72, v72
    s_add_u32 s42, s47, 1
    v_exp_f32 v73, v73
    s_and_b32 s42, s42, 15
    v_exp_f32 v74, v74
    s_mul_i32 s48, s42, 28672
    v_exp_f32 v75, v75
    s_add_u32 s48, s48, s45
    v_exp_f32 v76, v76
    buffer_load_dwordx4 v[160:163], v2, s[20:23], s48 offen offset:0 sc1
    v_exp_f32 v77, v77
    buffer_load_dwordx4 v[164:167], v2, s[20:23], s48 offen offset:1024 sc1
    v_exp_f32 v78, v78
    v_mov_b32 v168, 0x3f803f80
    v_exp_f32 v79, v79
    v_mov_b32 v169, 0x3f803f80
    v_add_f32 v72, 1.0, v72
    v_mov_b32 v170, 0x3f803f80
    v_add_f32 v73, 1.0, v73
    v_mov_b32 v171, 0x3f803f80
    v_add_f32 v74, 1.0, v74
    v_mov_b32 v172, 0x3f803f80
    v_add_f32 v75, 1.0, v75
    v_mov_b32 v173, 0x3f803f80
    v_add_f32 v76, 1.0, v76
    v_mov_b32 v174, 0x3f803f80
    v_add_f32 v77, 1.0, v77
    v_mov_b32 v175, 0x3f803f80
    v_add_f32 v78, 1.0, v78
    s_add_u32 s42, s47, 2
    v_add_f32 v79, 1.0, v79
    s_and_b32 s42, s42, 15
    v_rcp_f32 v72, v72
    s_mul_i32 s48, s42, 28672
    v_rcp_f32 v73, v73
    s_add_u32 s48, s48, s45
    v_rcp_f32 v74, v74
    buffer_load_dwordx4 v[176:179], v2, s[20:23], s48 offen offset:0 sc1
    v_rcp_f32 v75, v75
    buffer_load_dwordx4 v[180:183], v2, s[20:23], s48 offen offset:1024 sc1
    v_rcp_f32 v76, v76
    v_mov_b32 v184, 0x3f803f80
    v_rcp_f32 v77, v77
    v_mov_b32 v185, 0x3f803f80
    v_rcp_f32 v78, v78
    v_mov_b32 v186, 0x3f803f80
    v_rcp_f32 v79, v79
    v_mov_b32 v187, 0x3f803f80
    v_mul_f32 v208, v208, v72
    v_mov_b32 v188, 0x3f803f80
    v_mul_f32 v209, v209, v73
    v_mov_b32 v189, 0x3f803f80
    v_mul_f32 v210, v210, v74
    v_mov_b32 v190, 0x3f803f80
    v_mul_f32 v211, v211, v75
    v_mov_b32 v191, 0x3f803f80
    v_mul_f32 v212, v212, v76
    v_mul_f32 v213, v213, v77
    v_mul_f32 v214, v214, v78
    v_mul_f32 v215, v215, v79
    v_mul_f32 v216, v216, v208
    v_mul_f32 v217, v217, v209
    v_mul_f32 v218, v218, v210
    v_mul_f32 v219, v219, v211
    v_mul_f32 v220, v220, v212
    v_mul_f32 v221, v221, v213
    v_mul_f32 v222, v222, v214
    v_mul_f32 v223, v223, v215
    v_cvt_pk_bf16_f32 v244, v216, v217
    v_cvt_pk_bf16_f32 v245, v218, v219
    v_cvt_pk_bf16_f32 v246, v220, v221
    v_cvt_pk_bf16_f32 v247, v222, v223
    s_branch att_main
k1_epi:
    v_mul_f32 v72, s60, v208
    v_mul_f32 v73, s60, v209
    v_mul_f32 v74, s60, v210
    v_mul_f32 v75, s60, v211
    v_mul_f32 v76, s60, v212
    v_mul_f32 v77, s60, v213
    v_mul_f32 v78, s60, v214
    v_mul_f32 v79, s60, v215
    v_exp_f32 v72, v72
    v_exp_f32 v73, v73
    v_exp_f32 v74, v74
    v_exp_f32 v75, v75
    v_exp_f32 v76, v76
    v_exp_f32 v77, v77
    v_exp_f32 v78, v78
    v_exp_f32 v79, v79
    v_add_f32 v72, 1.0, v72
    v_add_f32 v73, 1.0, v73
    v_add_f32 v74, 1.0, v74
    v_add_f32 v75, 1.0, v75
    v_add_f32 v76, 1.0, v76
    v_add_f32 v77, 1.0, v77
    v_add_f32 v78, 1.0, v78
    v_add_f32 v79, 1.0, v79
    v_rcp_f32 v72, v72
    v_rcp_f32 v73, v73
    v_rcp_f32 v74, v74
    v_rcp_f32 v75, v75
    v_rcp_f32 v76, v76
    v_rcp_f32 v77, v77
    v_rcp_f32 v78, v78
    v_rcp_f32 v79, v79
    v_mul_f32 v208, v208, v72
    v_mul_f32 v209, v209, v73
    v_mul_f32 v210, v210, v74
    v_mul_f32 v211, v211, v75
    v_mul_f32 v212, v212, v76
    v_mul_f32 v213, v213, v77
    v_mul_f32 v214, v214, v78
    v_mul_f32 v215, v215, v79
    v_mul_f32 v216, v216, v208
    v_mul_f32 v217, v217, v209
    v_mul_f32 v218, v218, v210
    v_mul_f32 v219, v219, v211
    v_mul_f32 v220, v220, v212
    v_mul_f32 v221, v221, v213
    v_mul_f32 v222, v222, v214
    v_mul_f32 v223, v223, v215
    v_cvt_pk_bf16_f32 v244, v216, v217
    v_cvt_pk_bf16_f32 v245, v218, v219
    v_cvt_pk_bf16_f32 v246, v220, v221
    v_cvt_pk_bf16_f32 v247, v222, v223
    s_cmp_ge_u32 s38, 4
    s_cbranch_scc1 gemm_role_f
    s_cmp_lg_u32 s38, 0
    s_cbranch_scc1 aq_lw
    s_mov_b32 s63, 1048576
    s_branch aq_chk
gemm_role_f:
    v_mov_b32 v3, 155680
lw2:
    ds_read_b32 v4, v3
    s_waitcnt lgkmcnt(0)
    v_readfirstlane_b32 s42, v4
    s_cmp_eq_u32 s42, 8
    s_cbranch_scc1 lwd2
    s_sleep 1
    s_branch lw2
lwd2:
    s_branch gemm_role2
k1_v:
    v_add_u32 v11, 2176, v9
    s_cmp_eq_u32 s37, 14
    s_cselect_b32 s42, 0, 512
    s_add_u32 s42, s42, 1792
    v_add_u32 v9, s42, v9
    s_mov_b32 s18, 896
    s_waitcnt lgkmcnt(0)
    s_mov_b64 s[4:5], s[64:65]
    s_mov_b64 s[8:9], s[66:67]
    s_mov_b64 s[16:17], s[78:79]
    s_add_u32 m0, s45, 0
    s_mov_b32 s47, 0
    buffer_load_dwordx4 v7, s[4:7], s47 offen lds
    s_add_u32 m0, s45, 1024
    s_mov_b32 s47, 0
    buffer_load_dwordx4 v8, s[4:7], s47 offen lds
    s_add_u32 m0, s46, 0
    s_mov_b32 s47, 0
    buffer_load_dwordx4 v9, s[8:11], s47 offen lds
    s_add_u32 m0, s46, 8192
    s_mov_b32 s47, 128
    buffer_load_dwordx4 v9, s[8:11], s47 offen lds
    s_add_u32 m0, s46, 16384
    s_mov_b32 s47, 256
    buffer_load_dwordx4 v9, s[8:11], s47 offen lds
    s_barrier
    s_lshl_b32 s58, s2, 3
    s_add_u32 s58, s58, s38
    s_lshl_b32 s42, s58, 10
    s_mov_b32 s27, 0x00020000
    v_lshrrev_b32 v30, 3, v1
    v_lshlrev_b32 v30, 7, v30
    v_add_u32 v30, v30, v2
    s_cmp_lt_u32 s58, 672
    s_cbranch_scc1 k_pf_q_v
    s_cmp_lt_u32 s58, 1120
    s_cselect_b32 s24, s72, s74
    s_cselect_b32 s25, s73, s75
    s_cselect_b32 s42, 0, 448
    s_mov_b32 s26, 1605632
    s_sub_u32 s42, s58, s42
    s_lshl_b32 s42, s42, 11
    s_add_u32 s42, s42, 4294279168
    buffer_load_dwordx4 v[208:211], v30, s[24:27], s42 offen
    s_branch k_pf_d_v
k_pf_q_v:
    s_add_u32 s42, s42, 516096
    buffer_load_dwordx4 v[208:211], v2, s[8:11], s42 offen
k_pf_d_v:
    s_add_u32 m0, s45, 40960
    s_mov_b32 s47, 128
    buffer_load_dwordx4 v7, s[4:7], s47 offen lds
    s_add_u32 m0, s45, 41984
    s_mov_b32 s47, 128
    buffer_load_dwordx4 v8, s[4:7], s47 offen lds
    s_add_u32 m0, s46, 40960
    s_mov_b32 s47, 172032
    buffer_load_dwordx4 v9, s[8:11], s47 offen lds
    s_add_u32 m0, s46, 49152
    s_mov_b32 s47, 172160
    buffer_load_dwordx4 v9, s[8:11], s47 offen lds
    s_add_u32 m0, s46, 57344
    s_mov_b32 s47, 172288
    buffer_load_dwordx4 v9, s[8:11], s47 offen lds
    s_mov_b32 s20, s84
    s_mov_b32 s21, s85
    s_mov_b32 s22, 33554432
    s_mov_b32 s23, 0x00020000
    s_mov_b32 s32, s82
    s_mov_b32 s33, s83
    s_mov_b32 s34, 256
    s_mov_b32 s35, 0x00020000
    s_mov_b32 s28, s76
    s_mov_b32 s29, s77
    s_mov_b32 s30, 1605632
    s_mov_b32 s31, 0x00020000
    s_or_b32 s42, s2, s38
    s_cmp_lg_u32 s42, 0
    s_cbranch_scc1 k_nononce_v
    s_memrealtime s[48:49]
    v_mov_b32 v4, 0
    s_waitcnt lgkmcnt(0)
    s_or_b32 s42, s48, 0x80000000
    v_mov_b32 v3, s42
    s_mov_b64 exec, 1
    buffer_store_dword v3, v4, s[32:35], 0 offen sc1
    s_mov_b64 exec, -1
k_nononce_v:
    s_cmp_lt_u32 s58, 784
    s_cselect_b32 s24, s72, s74
    s_cselect_b32 s25, s73, s75
    s_cselect_b32 s42, 0, 784
    s_mov_b32 s26, 1605632
    s_sub_u32 s42, s58, s42
    s_lshl_b32 s42, s42, 11
    buffer_load_dwordx4 v[212:215], v30, s[24:27], s42 offen offset:128
    s_cmp_lt_u32 s58, 1568
    s_cselect_b32 s24, s76, s68
    s_cselect_b32 s25, s77, s69
    s_cselect_b32 s42, 0, 1568
    s_cselect_b32 s26, s30, 401408
    s_sub_u32 s42, s58, s42
    s_lshl_b32 s42, s42, 10
    buffer_load_dwordx4 v[216:219], v2, s[24:27], s42 offen
    s_sub_u32 s42, s62, 28
    s_cmp_ge_u32 s42, 4
    s_cbranch_scc1 k_nocp_v
    s_lshl_b32 s42, s42, 3
    s_add_u32 s42, s42, s38
    s_lshl_b32 s42, s42, 10
    v_add_u32 v3, s42, v2
    v_min_u32 v3, k_end-gated_mix__softmax_full_mha__swiglu_ffn__prompt_kernel-12, v3
    s_getpc_b64 s[48:49]
k_pc_v:
    s_sub_u32 s48, s48, k_pc_v-gated_mix__softmax_full_mha__swiglu_ffn__prompt_kernel
    s_subb_u32 s49, s49, 0
    v_mov_b32 v5, s49
    v_add_co_u32 v4, vcc, s48, v3
    s_nop 1
    v_addc_co_u32 v5, vcc, 0, v5, vcc
    global_load_dwordx4 v[220:223], v[4:5], off
k_nocp_v:
    s_and_b32 s39, s38, 3
    s_lshr_b32 s40, s38, 2
    s_lshl_b32 s49, s36, 2
    s_add_u32 s49, s49, s39
    v_and_b32 v3, 31, v1
    v_lshrrev_b32 v4, 5, v1
    v_bfe_u32 v5, v1, 1, 3
    v_xor_b32 v5, v5, v4
    s_lshl_b32 s42, s39, 12
    v_lshlrev_b32 v6, 7, v3
    v_lshl_add_u32 v6, v5, 4, v6
    v_add_u32 v14, s42, v6
    v_xor_b32 v15, 32, v14
    v_xor_b32 v16, 64, v14
    v_xor_b32 v17, 96, v14
    v_bfe_u32 v26, v1, 4, 1
    v_bfe_u32 v27, v1, 2, 2
    v_and_b32 v28, 3, v1
    v_lshl_add_u32 v29, v4, 3, v27
    v_and_b32 v5, 2, v27
    v_xor_b32 v5, v5, v26
    s_lshl_b32 s42, s40, 1
    v_xor_b32 v5, s42, v5
    v_lshlrev_b32 v6, 7, v29
    v_lshl_add_u32 v6, v5, 5, v6
    v_lshl_add_u32 v6, v28, 3, v6
    v_add_u32 v18, 16384, v6
    s_mov_b32 s60, 0xbfb8aa3b
    v_add_u32 v19, 8192, v18
    v_add_u32 v20, 16384, v18
    s_sub_u32 s43, s37, 14
    s_lshl_b32 s43, s43, 6
    v_xor_b32 v21, s43, v18
    v_lshlrev_b32 v23, 4, v4
    v_add_u32 v23, 156672, v23
    s_cmp_eq_u32 s37, 14
    s_cselect_b32 s43, 0, 4096
    s_lshl_b32 s44, s40, 9
    s_add_u32 s43, s43, s44
    s_mul_i32 s50, s49, 28672
    s_add_u32 s50, s50, s43
    s_add_u32 s50, s50, 4194304
    s_add_u32 s51, s50, 14336
    v_mul_u32_u24 v22, 6656, v4
    v_add_u32 v22, v22, v2
    s_waitcnt vmcnt(8)
    s_barrier
    ds_read_b128 v[32:35], v14 offset:0
    ds_read_b64_tr_b16 v[224:225], v18 offset:0
    ds_read_b64_tr_b16 v[226:227], v18 offset:512
    ds_read_b64_tr_b16 v[228:229], v19 offset:0
    ds_read_b64_tr_b16 v[230:231], v19 offset:512
    ds_read_b64_tr_b16 v[232:233], v20 offset:0
    ds_read_b64_tr_b16 v[234:235], v20 offset:512
    ds_read_b128 v[36:39], v15 offset:0
    ds_read_b64_tr_b16 v[236:237], v18 offset:2048
    ds_read_b64_tr_b16 v[238:239], v18 offset:2560
    ds_read_b64_tr_b16 v[240:241], v19 offset:2048
    ds_read_b64_tr_b16 v[242:243], v19 offset:2560
    ds_read_b64_tr_b16 v[244:245], v20 offset:2048
    ds_read_b64_tr_b16 v[246:247], v20 offset:2560
    s_waitcnt lgkmcnt(7)
    v_mfma_f32_32x32x16_bf16 v[144:159], v[32:35], v[224:227], 0
    ds_read_b128 v[40:43], v16 offset:0
    ds_read_b64_tr_b16 v[192:193], v18 offset:4096
    ds_read_b64_tr_b16 v[194:195], v18 offset:4608
    v_mfma_f32_32x32x16_bf16 v[160:175], v[32:35], v[228:231], 0
    ds_read_b64_tr_b16 v[196:197], v19 offset:4096
    ds_read_b64_tr_b16 v[198:199], v19 offset:4608
    ds_read_b64_tr_b16 v[200:201], v20 offset:4096
    ds_read_b64_tr_b16 v[202:203], v20 offset:4608
    v_mfma_f32_32x32x16_bf16 v[176:191], v[32:35], v[232:235], 0
    s_add_u32 m0, s45, 81920
    s_mov_b32 s47, 256
    buffer_load_dwordx4 v7, s[4:7], s47 offen lds
    s_add_u32 m0, s45, 82944
    s_mov_b32 s47, 256
    buffer_load_dwordx4 v8, s[4:7], s47 offen lds
    s_waitcnt lgkmcnt(7)
    v_mfma_f32_32x32x16_bf16 v[144:159], v[36:39], v[236:239], v[144:159]
    ds_read_b128 v[44:47], v17 offset:0
    ds_read_b64_tr_b16 v[224:225], v18 offset:6144
    ds_read_b64_tr_b16 v[226:227], v18 offset:6656
    v_mfma_f32_32x32x16_bf16 v[160:175], v[36:39], v[240:243], v[160:175]
    ds_read_b64_tr_b16 v[228:229], v19 offset:6144
    ds_read_b64_tr_b16 v[230:231], v19 offset:6656
    ds_read_b64_tr_b16 v[232:233], v20 offset:6144
    ds_read_b64_tr_b16 v[234:235], v20 offset:6656
    v_mfma_f32_32x32x16_bf16 v[176:191], v[36:39], v[244:247], v[176:191]
    s_add_u32 m0, s46, 81920
    s_mov_b32 s47, 344064
    buffer_load_dwordx4 v9, s[8:11], s47 offen lds
    s_add_u32 m0, s46, 90112
    s_mov_b32 s47, 344192
    buffer_load_dwordx4 v9, s[8:11], s47 offen lds
    s_waitcnt vmcnt(6) lgkmcnt(0)
    s_barrier
    v_mfma_f32_32x32x16_bf16 v[144:159], v[40:43], v[192:195], v[144:159]
    ds_read_b128 v[48:51], v14 offset:40960
    ds_read_b64_tr_b16 v[236:237], v18 offset:40960
    ds_read_b64_tr_b16 v[238:239], v18 offset:41472
    v_mfma_f32_32x32x16_bf16 v[160:175], v[40:43], v[196:199], v[160:175]
    ds_read_b64_tr_b16 v[240:241], v19 offset:40960
    ds_read_b64_tr_b16 v[242:243], v19 offset:41472
    ds_read_b64_tr_b16 v[244:245], v20 offset:40960
    ds_read_b64_tr_b16 v[246:247], v20 offset:41472
    v_mfma_f32_32x32x16_bf16 v[176:191], v[40:43], v[200:203], v[176:191]
    s_add_u32 m0, s46, 98304
    s_mov_b32 s47, 344320
    buffer_load_dwordx4 v9, s[8:11], s47 offen lds
    s_add_u32 m0, s45, 122880
    s_mov_b32 s47, 384
    buffer_load_dwordx4 v7, s[4:7], s47 offen lds
    s_waitcnt lgkmcnt(7)
    v_mfma_f32_32x32x16_bf16 v[144:159], v[44:47], v[224:227], v[144:159]
    ds_read_b128 v[52:55], v15 offset:40960
    ds_read_b64_tr_b16 v[192:193], v18 offset:43008
    ds_read_b64_tr_b16 v[194:195], v18 offset:43520
    v_mfma_f32_32x32x16_bf16 v[160:175], v[44:47], v[228:231], v[160:175]
    ds_read_b64_tr_b16 v[196:197], v19 offset:43008
    ds_read_b64_tr_b16 v[198:199], v19 offset:43520
    ds_read_b64_tr_b16 v[200:201], v20 offset:43008
    ds_read_b64_tr_b16 v[202:203], v20 offset:43520
    v_mfma_f32_32x32x16_bf16 v[176:191], v[44:47], v[232:235], v[176:191]
    s_add_u32 m0, s45, 123904
    s_mov_b32 s47, 384
    buffer_load_dwordx4 v8, s[4:7], s47 offen lds
    s_add_u32 m0, s46, 122880
    s_mov_b32 s47, 516096
    buffer_load_dwordx4 v9, s[8:11], s47 offen lds
    s_waitcnt lgkmcnt(7)
    v_mfma_f32_32x32x16_bf16 v[144:159], v[48:51], v[236:239], v[144:159]
    ds_read_b128 v[56:59], v16 offset:40960
    ds_read_b64_tr_b16 v[224:225], v18 offset:45056
    ds_read_b64_tr_b16 v[226:227], v18 offset:45568
    v_mfma_f32_32x32x16_bf16 v[160:175], v[48:51], v[240:243], v[160:175]
    ds_read_b64_tr_b16 v[228:229], v19 offset:45056
    ds_read_b64_tr_b16 v[230:231], v19 offset:45568
    ds_read_b64_tr_b16 v[232:233], v20 offset:45056
    ds_read_b64_tr_b16 v[234:235], v20 offset:45568
    v_mfma_f32_32x32x16_bf16 v[176:191], v[48:51], v[244:247], v[176:191]
    s_add_u32 m0, s46, 131072
    s_mov_b32 s47, 516224
    buffer_load_dwordx4 v9, s[8:11], s47 offen lds
    s_add_u32 m0, s46, 139264
    s_mov_b32 s47, 516352
    buffer_load_dwordx4 v9, s[8:11], s47 offen lds
    s_waitcnt lgkmcnt(7)
    v_mfma_f32_32x32x16_bf16 v[144:159], v[52:55], v[192:195], v[144:159]
    ds_read_b128 v[60:63], v17 offset:40960
    ds_read_b64_tr_b16 v[236:237], v18 offset:47104
    ds_read_b64_tr_b16 v[238:239], v18 offset:47616
    v_mfma_f32_32x32x16_bf16 v[160:175], v[52:55], v[196:199], v[160:175]
    ds_read_b64_tr_b16 v[240:241], v19 offset:47104
    ds_read_b64_tr_b16 v[242:243], v19 offset:47616
    ds_read_b64_tr_b16 v[244:245], v20 offset:47104
    ds_read_b64_tr_b16 v[246:247], v20 offset:47616
    v_mfma_f32_32x32x16_bf16 v[176:191], v[52:55], v[200:203], v[176:191]
    s_add_u32 m0, s45, 0
    s_mov_b32 s47, 512
    buffer_load_dwordx4 v7, s[4:7], s47 offen lds
    s_add_u32 m0, s45, 1024
    s_mov_b32 s47, 512
    buffer_load_dwordx4 v8, s[4:7], s47 offen lds
    s_waitcnt vmcnt(7) lgkmcnt(0)
    s_barrier
    v_mfma_f32_32x32x16_bf16 v[144:159], v[56:59], v[224:227], v[144:159]
    v_add_u32 v14, 81920, v14
    v_add_u32 v15, 81920, v15
    v_add_u32 v16, 81920, v16
    v_add_u32 v17, 81920, v17
    v_add_u32 v18, 81920, v18
    v_add_u32 v19, 81920, v19
    v_add_u32 v20, 81920, v20
    v_add_u32 v21, 81920, v21
    ds_read_b128 v[64:67], v14 offset:0
    ds_read_b64_tr_b16 v[192:193], v18 offset:0
    ds_read_b64_tr_b16 v[194:195], v18 offset:512
    v_mfma_f32_32x32x16_bf16 v[160:175], v[56:59], v[228:231], v[160:175]
    ds_read_b64_tr_b16 v[196:197], v19 offset:0
    ds_read_b64_tr_b16 v[198:199], v19 offset:512
    ds_read_b64_tr_b16 v[200:201], v20 offset:0
    ds_read_b64_tr_b16 v[202:203], v20 offset:512
    v_mfma_f32_32x32x16_bf16 v[176:191], v[56:59], v[232:235], v[176:191]
    s_add_u32 m0, s46, 0
    s_mov_b32 s47, 688128
    buffer_load_dwordx4 v9, s[8:11], s47 offen lds
    s_add_u32 m0, s46, 8192
    s_mov_b32 s47, 688256
    buffer_load_dwordx4 v9, s[8:11], s47 offen lds
    s_waitcnt lgkmcnt(7)
    v_mfma_f32_32x32x16_bf16 v[144:159], v[60:63], v[236:239], v[144:159]
    ds_read_b128 v[68:71], v15 offset:0
    ds_read_b64_tr_b16 v[224:225], v18 offset:2048
    ds_read_b64_tr_b16 v[226:227], v18 offset:2560
    v_mfma_f32_32x32x16_bf16 v[160:175], v[60:63], v[240:243], v[160:175]
    ds_read_b64_tr_b16 v[228:229], v19 offset:2048
    ds_read_b64_tr_b16 v[230:231], v19 offset:2560
    ds_read_b64_tr_b16 v[232:233], v20 offset:2048
    ds_read_b64_tr_b16 v[234:235], v20 offset:2560
    v_mfma_f32_32x32x16_bf16 v[176:191], v[60:63], v[244:247], v[176:191]
    s_add_u32 m0, s46, 16384
    s_mov_b32 s47, 688384
    buffer_load_dwordx4 v9, s[8:11], s47 offen lds
    s_add_u32 m0, s45, 40960
    s_mov_b32 s47, 640
    buffer_load_dwordx4 v7, s[4:7], s47 offen lds
    s_waitcnt lgkmcnt(7)
    v_mfma_f32_32x32x16_bf16 v[144:159], v[64:67], v[192:195], v[144:159]
    ds_read_b128 v[72:75], v16 offset:0
    ds_read_b64_tr_b16 v[236:237], v18 offset:4096
    ds_read_b64_tr_b16 v[238:239], v18 offset:4608
    v_mfma_f32_32x32x16_bf16 v[160:175], v[64:67], v[196:199], v[160:175]
    ds_read_b64_tr_b16 v[240:241], v19 offset:4096
    ds_read_b64_tr_b16 v[242:243], v19 offset:4608
    ds_read_b64_tr_b16 v[244:245], v20 offset:4096
    ds_read_b64_tr_b16 v[246:247], v20 offset:4608
    v_mfma_f32_32x32x16_bf16 v[176:191], v[64:67], v[200:203], v[176:191]
    s_add_u32 m0, s45, 41984
    s_mov_b32 s47, 640
    buffer_load_dwordx4 v8, s[4:7], s47 offen lds
    s_waitcnt lgkmcnt(7)
    v_mfma_f32_32x32x16_bf16 v[144:159], v[68:71], v[224:227], v[144:159]
    ds_read_b128 v[76:79], v17 offset:0
    ds_read_b64_tr_b16 v[192:193], v18 offset:6144
    ds_read_b64_tr_b16 v[194:195], v18 offset:6656
    v_mfma_f32_32x32x16_bf16 v[160:175], v[68:71], v[228:231], v[160:175]
    ds_read_b64_tr_b16 v[196:197], v19 offset:6144
    ds_read_b64_tr_b16 v[198:199], v19 offset:6656
    ds_read_b64_tr_b16 v[200:201], v20 offset:6144
    ds_read_b64_tr_b16 v[202:203], v20 offset:6656
    v_mfma_f32_32x32x16_bf16 v[176:191], v[68:71], v[232:235], v[176:191]
    s_add_u32 m0, s46, 40960
    s_mov_b32 s47, 860160
    buffer_load_dwordx4 v9, s[8:11], s47 offen lds
    s_waitcnt vmcnt(8) lgkmcnt(0)
    s_barrier
    v_mfma_f32_32x32x16_bf16 v[144:159], v[72:75], v[236:239], v[144:159]
    ds_read_b128 v[80:83], v14 offset:40960
    ds_read_b64_tr_b16 v[224:225], v18 offset:40960
    ds_read_b64_tr_b16 v[226:227], v18 offset:41472
    v_mfma_f32_32x32x16_bf16 v[160:175], v[72:75], v[240:243], v[160:175]
    ds_read_b64_tr_b16 v[228:229], v19 offset:40960
    ds_read_b64_tr_b16 v[230:231], v19 offset:41472
    ds_read_b64_tr_b16 v[232:233], v20 offset:40960
    ds_read_b64_tr_b16 v[234:235], v20 offset:41472
    v_mfma_f32_32x32x16_bf16 v[176:191], v[72:75], v[244:247], v[176:191]
    s_add_u32 m0, s46, 49152
    s_mov_b32 s47, 860288
    buffer_load_dwordx4 v9, s[8:11], s47 offen lds
    s_add_u32 m0, s46, 57344
    s_mov_b32 s47, 860416
    buffer_load_dwordx4 v9, s[8:11], s47 offen lds
    s_waitcnt lgkmcnt(7)
    v_mfma_f32_32x32x16_bf16 v[144:159], v[76:79], v[192:195], v[144:159]
    ds_read_b128 v[84:87], v15 offset:40960
    ds_read_b64_tr_b16 v[236:237], v18 offset:43008
    ds_read_b64_tr_b16 v[238:239], v18 offset:43520
    v_mfma_f32_32x32x16_bf16 v[160:175], v[76:79], v[196:199], v[160:175]
    ds_read_b64_tr_b16 v[240:241], v19 offset:43008
    ds_read_b64_tr_b16 v[242:243], v19 offset:43520
    ds_read_b64_tr_b16 v[244:245], v20 offset:43008
    ds_read_b64_tr_b16 v[246:247], v20 offset:43520
    v_mfma_f32_32x32x16_bf16 v[176:191], v[76:79], v[200:203], v[176:191]
    s_add_u32 m0, s45, 81920
    s_mov_b32 s47, 768
    buffer_load_dwordx4 v7, s[4:7], s47 offen lds
    s_add_u32 m0, s45, 82944
    s_mov_b32 s47, 768
    buffer_load_dwordx4 v8, s[4:7], s47 offen lds
    s_waitcnt lgkmcnt(7)
    v_mfma_f32_32x32x16_bf16 v[144:159], v[80:83], v[224:227], v[144:159]
    ds_read_b128 v[88:91], v16 offset:40960
    ds_read_b64_tr_b16 v[192:193], v18 offset:45056
    ds_read_b64_tr_b16 v[194:195], v18 offset:45568
    v_mfma_f32_32x32x16_bf16 v[160:175], v[80:83], v[228:231], v[160:175]
    ds_read_b64_tr_b16 v[196:197], v19 offset:45056
    ds_read_b64_tr_b16 v[198:199], v19 offset:45568
    ds_read_b64_tr_b16 v[200:201], v20 offset:45056
    ds_read_b64_tr_b16 v[202:203], v20 offset:45568
    v_mfma_f32_32x32x16_bf16 v[176:191], v[80:83], v[232:235], v[176:191]
    s_add_u32 m0, s46, 81920
    s_mov_b32 s47, 1032192
    buffer_load_dwordx4 v9, s[8:11], s47 offen lds
    s_waitcnt lgkmcnt(7)
    v_mfma_f32_32x32x16_bf16 v[144:159], v[84:87], v[236:239], v[144:159]
    ds_read_b128 v[92:95], v17 offset:40960
    ds_read_b64_tr_b16 v[224:225], v18 offset:47104
    ds_read_b64_tr_b16 v[226:227], v18 offset:47616
    v_mfma_f32_32x32x16_bf16 v[160:175], v[84:87], v[240:243], v[160:175]
    ds_read_b64_tr_b16 v[228:229], v19 offset:47104
    ds_read_b64_tr_b16 v[230:231], v19 offset:47616
    ds_read_b64_tr_b16 v[232:233], v20 offset:47104
    ds_read_b64_tr_b16 v[234:235], v20 offset:47616
    v_mfma_f32_32x32x16_bf16 v[176:191], v[84:87], v[244:247], v[176:191]
    s_add_u32 m0, s46, 90112
    s_mov_b32 s47, 1032320
    buffer_load_dwordx4 v9, s[8:11], s47 offen lds
    s_waitcnt vmcnt(9) lgkmcnt(0)
    s_barrier
    v_mfma_f32_32x32x16_bf16 v[144:159], v[88:91], v[192:195], v[144:159]
    v_subrev_u32 v14, 81920, v14
    v_subrev_u32 v15, 81920, v15
    v_subrev_u32 v16, 81920, v16
    v_subrev_u32 v17, 81920, v17
    v_subrev_u32 v18, 81920, v18
    v_subrev_u32 v19, 81920, v19
    v_subrev_u32 v20, 81920, v20
    v_subrev_u32 v21, 81920, v21
    ds_read_b128 v[96:99], v14 offset:0
    ds_read_b64_tr_b16 v[236:237], v18 offset:0
    ds_read_b64_tr_b16 v[238:239], v18 offset:512
    v_mfma_f32_32x32x16_bf16 v[160:175], v[88:91], v[196:199], v[160:175]
    ds_read_b64_tr_b16 v[240:241], v19 offset:0
    ds_read_b64_tr_b16 v[242:243], v19 offset:512
    ds_read_b64_tr_b16 v[244:245], v20 offset:0
    ds_read_b64_tr_b16 v[246:247], v20 offset:512
    v_mfma_f32_32x32x16_bf16 v[176:191], v[88:91], v[200:203], v[176:191]
    s_add_u32 m0, s46, 98304
    s_mov_b32 s47, 1032448
    buffer_load_dwordx4 v9, s[8:11], s47 offen lds
    v_mov_b32 v13, 0
    buffer_load_dword v13, v13, s[32:35], 0 offen sc1
    s_waitcnt lgkmcnt(7)
    v_mfma_f32_32x32x16_bf16 v[144:159], v[92:95], v[224:227], v[144:159]
    ds_read_b128 v[100:103], v15 offset:0
    ds_read_b64_tr_b16 v[192:193], v18 offset:2048
    ds_read_b64_tr_b16 v[194:195], v18 offset:2560
    v_mfma_f32_32x32x16_bf16 v[160:175], v[92:95], v[228:231], v[160:175]
    ds_read_b64_tr_b16 v[196:197], v19 offset:2048
    ds_read_b64_tr_b16 v[198:199], v19 offset:2560
    ds_read_b64_tr_b16 v[200:201], v20 offset:2048
    ds_read_b64_tr_b16 v[202:203], v20 offset:2560
    v_mfma_f32_32x32x16_bf16 v[176:191], v[92:95], v[232:235], v[176:191]
    s_add_u32 m0, s46, 106496
    s_mov_b32 s47, 0
    buffer_load_dwordx4 v11, s[8:11], s47 offen lds
    s_waitcnt lgkmcnt(7)
    v_mfma_f32_32x32x16_bf16 v[144:159], v[96:99], v[236:239], v[144:159]
    ds_read_b128 v[104:107], v16 offset:0
    ds_read_b64_tr_b16 v[224:225], v18 offset:4096
    ds_read_b64_tr_b16 v[226:227], v18 offset:4608
    v_mfma_f32_32x32x16_bf16 v[160:175], v[96:99], v[240:243], v[160:175]
    ds_read_b64_tr_b16 v[228:229], v19 offset:4096
    ds_read_b64_tr_b16 v[230:231], v19 offset:4608
    ds_read_b64_tr_b16 v[232:233], v20 offset:4096
    ds_read_b64_tr_b16 v[234:235], v20 offset:4608
    v_mfma_f32_32x32x16_bf16 v[176:191], v[96:99], v[244:247], v[176:191]
    s_lshl_b32 s70, s61, 1
    s_and_b32 s44, s62, 1
    s_add_u32 s70, s70, s44
    s_lshr_b32 s71, s62, 1
    s_lshl_b32 s41, s61, 2
    s_and_b32 s44, s62, 3
    s_add_u32 s41, s41, s44
    s_add_u32 m0, s46, 114688
    s_mov_b32 s47, 172032
    buffer_load_dwordx4 v11, s[8:11], s47 offen lds
    s_waitcnt lgkmcnt(7)
    v_mfma_f32_32x32x16_bf16 v[144:159], v[100:103], v[192:195], v[144:159]
    ds_read_b128 v[108:111], v17 offset:0
    ds_read_b64_tr_b16 v[236:237], v18 offset:6144
    ds_read_b64_tr_b16 v[238:239], v18 offset:6656
    v_mfma_f32_32x32x16_bf16 v[160:175], v[100:103], v[196:199], v[160:175]
    ds_read_b64_tr_b16 v[240:241], v19 offset:6144
    ds_read_b64_tr_b16 v[242:243], v19 offset:6656
    ds_read_b64_tr_b16 v[244:245], v20 offset:6144
    ds_read_b64_tr_b16 v[246:247], v20 offset:6656
    v_mfma_f32_32x32x16_bf16 v[176:191], v[100:103], v[200:203], v[176:191]
    s_lshr_b32 s3, s62, 2
    s_mul_i32 s57, s70, 7
    s_lshr_b32 s57, s57, 1
    s_lshl_b32 s56, s70, 12
    s_add_u32 s56, s56, 16842752
    s_lshr_b32 s43, s71, 2
    s_lshl_b32 s43, s43, 7
    s_add_u32 m0, s46, 122880
    s_mov_b32 s47, 344064
    buffer_load_dwordx4 v11, s[8:11], s47 offen lds
    s_waitcnt vmcnt(9) lgkmcnt(0)
    s_barrier
    v_mfma_f32_32x32x16_bf16 v[144:159], v[104:107], v[224:227], v[144:159]
    ds_read_b128 v[112:115], v14 offset:40960
    ds_read_b64_tr_b16 v[192:193], v18 offset:40960
    ds_read_b64_tr_b16 v[194:195], v18 offset:41472
    v_mfma_f32_32x32x16_bf16 v[160:175], v[104:107], v[228:231], v[160:175]
    ds_read_b64_tr_b16 v[196:197], v19 offset:40960
    ds_read_b64_tr_b16 v[198:199], v19 offset:41472
    ds_read_b64_tr_b16 v[200:201], v20 offset:40960
    ds_read_b64_tr_b16 v[202:203], v20 offset:41472
    v_mfma_f32_32x32x16_bf16 v[176:191], v[104:107], v[232:235], v[176:191]
    s_and_b32 s44, s71, 3
    s_lshl_b32 s44, s44, 2
    s_add_u32 s43, s43, s44
    s_add_u32 s43, s43, 2048
    v_lshrrev_b32 v26, 2, v1
    v_and_b32 v27, 3, v1
    v_lshlrev_b32 v27, 2, v27
    s_add_u32 m0, s46, 131072
    s_mov_b32 s47, 516096
    buffer_load_dwordx4 v11, s[8:11], s47 offen lds
    s_add_u32 m0, s46, 4294950912
    s_mov_b32 s47, 688128
    buffer_load_dwordx4 v11, s[8:11], s47 offen lds
    s_waitcnt lgkmcnt(7)
    v_mfma_f32_32x32x16_bf16 v[144:159], v[108:111], v[236:239], v[144:159]
    ds_read_b128 v[116:119], v15 offset:40960
    ds_read_b64_tr_b16 v[224:225], v18 offset:43008
    ds_read_b64_tr_b16 v[226:227], v18 offset:43520
    v_mfma_f32_32x32x16_bf16 v[160:175], v[108:111], v[240:243], v[160:175]
    ds_read_b64_tr_b16 v[228:229], v19 offset:43008
    ds_read_b64_tr_b16 v[230:231], v19 offset:43520
    ds_read_b64_tr_b16 v[232:233], v20 offset:43008
    ds_read_b64_tr_b16 v[234:235], v20 offset:43520
    v_mfma_f32_32x32x16_bf16 v[176:191], v[108:111], v[244:247], v[176:191]
    v_lshl_add_u32 v7, v26, 7, v27
    v_and_b32 v26, 1, v1
    v_lshl_add_u32 v8, v26, 9, s43
    v_and_b32 v26, 15, v1
    v_lshrrev_b32 v27, 4, v1
    v_lshlrev_b32 v29, 12, v26
    v_lshl_add_u32 v29, v27, 9, v29
    s_add_u32 m0, s46, 4294959104
    s_mov_b32 s47, 860160
    buffer_load_dwordx4 v11, s[8:11], s47 offen lds
    s_waitcnt lgkmcnt(7)
    v_mfma_f32_32x32x16_bf16 v[144:159], v[112:115], v[192:195], v[144:159]
    ds_read_b128 v[120:123], v16 offset:40960
    ds_read_b64_tr_b16 v[236:237], v18 offset:45056
    ds_read_b64_tr_b16 v[238:239], v18 offset:45568
    v_mfma_f32_32x32x16_bf16 v[160:175], v[112:115], v[196:199], v[160:175]
    ds_read_b64_tr_b16 v[240:241], v19 offset:45056
    ds_read_b64_tr_b16 v[242:243], v19 offset:45568
    ds_read_b64_tr_b16 v[244:245], v20 offset:45056
    ds_read_b64_tr_b16 v[246:247], v20 offset:45568
    v_mfma_f32_32x32x16_bf16 v[176:191], v[112:115], v[200:203], v[176:191]
    s_lshr_b32 s43, s36, 2
    s_lshl_b32 s43, s43, 7
    s_and_b32 s44, s36, 3
    s_lshl_b32 s44, s44, 2
    s_add_u32 s43, s43, s44
    v_add_u32 v28, 14, v27
    v_cmp_eq_u32 vcc, s37, v28
    s_add_u32 m0, s46, 0
    s_mov_b32 s47, 1032192
    buffer_load_dwordx4 v11, s[8:11], s47 offen lds
    s_waitcnt lgkmcnt(7)
    v_mfma_f32_32x32x16_bf16 v[144:159], v[116:119], v[224:227], v[144:159]
    ds_read_b128 v[124:127], v17 offset:40960
    ds_read_b64_tr_b16 v[192:193], v18 offset:47104
    ds_read_b64_tr_b16 v[194:195], v18 offset:47616
    v_mfma_f32_32x32x16_bf16 v[160:175], v[116:119], v[228:231], v[160:175]
    ds_read_b64_tr_b16 v[196:197], v19 offset:47104
    ds_read_b64_tr_b16 v[198:199], v19 offset:47616
    ds_read_b64_tr_b16 v[200:201], v20 offset:47104
    ds_read_b64_tr_b16 v[202:203], v20 offset:47616
    v_mfma_f32_32x32x16_bf16 v[176:191], v[116:119], v[232:235], v[176:191]
    s_add_u32 s43, s43, 1024
    v_add_u32 v29, s43, v29
    v_mov_b32 v26, 1073741824
    v_cndmask_b32 v10, v26, v29, vcc
    v_cmp_eq_u32 vcc, 0, v1
    s_lshr_b32 s55, s49, 1
    s_lshl_b32 s55, s55, 10
    s_mov_b32 m0, 156672
    s_nop 0
    buffer_load_dwordx4 v2, s[16:19], 0 offen lds
    s_waitcnt vmcnt(9) lgkmcnt(0)
    s_barrier
    v_mfma_f32_32x32x16_bf16 v[144:159], v[120:123], v[236:239], v[144:159]
    v_add_u32 v14, 81920, v14
    v_add_u32 v15, 81920, v15
    v_add_u32 v16, 81920, v16
    v_add_u32 v17, 81920, v17
    v_add_u32 v18, 81920, v18
    v_add_u32 v19, 81920, v19
    v_add_u32 v20, 81920, v20
    v_add_u32 v21, 81920, v21
    ds_read_b128 v[128:131], v14 offset:0
    ds_read_b64_tr_b16 v[224:225], v18 offset:0
    ds_read_b64_tr_b16 v[226:227], v18 offset:512
    v_mfma_f32_32x32x16_bf16 v[160:175], v[120:123], v[240:243], v[160:175]
    ds_read_b64_tr_b16 v[228:229], v19 offset:0
    ds_read_b64_tr_b16 v[230:231], v19 offset:512
    ds_read_b64_tr_b16 v[232:233], v20 offset:0
    ds_read_b64_tr_b16 v[234:235], v20 offset:512
    v_mfma_f32_32x32x16_bf16 v[176:191], v[120:123], v[244:247], v[176:191]
    v_cndmask_b32 v12, v26, v1, vcc
    s_lshr_b32 s43, s37, 1
    s_lshl_b32 s43, s43, 7
    s_add_u32 s55, s55, s43
    s_and_b32 s43, s37, 1
    s_lshl_b32 s43, s43, 3
    s_add_u32 s55, s55, s43
    s_waitcnt lgkmcnt(7)
    v_mfma_f32_32x32x16_bf16 v[144:159], v[124:127], v[192:195], v[144:159]
    ds_read_b128 v[132:135], v15 offset:0
    ds_read_b64_tr_b16 v[236:237], v18 offset:2048
    ds_read_b64_tr_b16 v[238:239], v18 offset:2560
    v_mfma_f32_32x32x16_bf16 v[160:175], v[124:127], v[196:199], v[160:175]
    ds_read_b64_tr_b16 v[240:241], v19 offset:2048
    ds_read_b64_tr_b16 v[242:243], v19 offset:2560
    ds_read_b64_tr_b16 v[244:245], v20 offset:2048
    ds_read_b64_tr_b16 v[246:247], v20 offset:2560
    v_mfma_f32_32x32x16_bf16 v[176:191], v[124:127], v[200:203], v[176:191]
    s_and_b32 s43, s39, 1
    s_lshl_b32 s43, s43, 2
    s_add_u32 s55, s55, s43
    s_add_u32 s55, s55, 16941056
    s_lshl_b32 s65, s36, 9
    s_lshr_b32 s43, s37, 2
    s_lshl_b32 s43, s43, 7
    s_waitcnt lgkmcnt(7)
    v_mfma_f32_32x32x16_bf16 v[144:159], v[128:131], v[224:227], v[144:159]
    ds_read_b128 v[136:139], v16 offset:0
    ds_read_b64_tr_b16 v[192:193], v18 offset:4096
    ds_read_b64_tr_b16 v[194:195], v18 offset:4608
    v_mfma_f32_32x32x16_bf16 v[160:175], v[128:131], v[228:231], v[160:175]
    ds_read_b64_tr_b16 v[196:197], v19 offset:4096
    ds_read_b64_tr_b16 v[198:199], v19 offset:4608
    ds_read_b64_tr_b16 v[200:201], v20 offset:4096
    ds_read_b64_tr_b16 v[202:203], v20 offset:4608
    v_mfma_f32_32x32x16_bf16 v[176:191], v[128:131], v[232:235], v[176:191]
    s_add_u32 s65, s65, s43
    s_and_b32 s43, s37, 3
    s_lshl_b32 s43, s43, 2
    s_add_u32 s65, s65, s43
    s_add_u32 s65, s65, 16908288
    s_lshl_b32 s54, s3, 7
    s_mul_i32 s53, s39, 14336
    s_waitcnt lgkmcnt(7)
    v_mfma_f32_32x32x16_bf16 v[144:159], v[132:135], v[236:239], v[144:159]
    ds_read_b128 v[140:143], v17 offset:0
    ds_read_b64_tr_b16 v[224:225], v18 offset:6144
    ds_read_b64_tr_b16 v[226:227], v18 offset:6656
    v_mfma_f32_32x32x16_bf16 v[160:175], v[132:135], v[240:243], v[160:175]
    ds_read_b64_tr_b16 v[228:229], v19 offset:6144
    ds_read_b64_tr_b16 v[230:231], v19 offset:6656
    ds_read_b64_tr_b16 v[232:233], v20 offset:6144
    ds_read_b64_tr_b16 v[234:235], v20 offset:6656
    v_mfma_f32_32x32x16_bf16 v[176:191], v[132:135], v[244:247], v[176:191]
    s_add_u32 s53, s53, s54
    s_lshl_b32 s54, s39, 11
    s_waitcnt vmcnt(0) lgkmcnt(0)
    v_readfirstlane_b32 s59, v13
    v_lshlrev_b32 v3, 2, v1
    v_add_u32 v3, 155648, v3
    v_mov_b32 v4, 0
    s_cmp_lg_u32 s59, 0
    s_cbranch_scc1 k1_nonce_ok_v
k1_nonce_spin_v:
    buffer_load_dword v13, v4, s[32:35], 0 offen sc1
    s_waitcnt vmcnt(0)
    v_readfirstlane_b32 s59, v13
    s_sleep 4
    s_cmp_eq_u32 s59, 0
    s_cbranch_scc1 k1_nonce_spin_v
k1_nonce_ok_v:
    ds_write_b32 v3, v4
    s_barrier
    v_mfma_f32_32x32x16_bf16 v[144:159], v[136:139], v[192:195], v[144:159]
    v_mfma_f32_32x32x16_bf16 v[160:175], v[136:139], v[196:199], v[160:175]
    v_mfma_f32_32x32x16_bf16 v[176:191], v[136:139], v[200:203], v[176:191]
    v_mfma_f32_32x32x16_bf16 v[144:159], v[140:143], v[224:227], v[144:159]
    v_mfma_f32_32x32x16_bf16 v[160:175], v[140:143], v[228:231], v[160:175]
    v_mfma_f32_32x32x16_bf16 v[176:191], v[140:143], v[232:235], v[176:191]
    s_cmp_eq_u32 s40, 1
    s_cbranch_scc1 k1_vg1
    v_add_u32 v21, 24576, v21
    ds_read_b64_tr_b16 v[248:249], v21 offset:0
    ds_read_b64_tr_b16 v[250:251], v21 offset:512
    ds_read_b64_tr_b16 v[252:253], v21 offset:2048
    ds_read_b64_tr_b16 v[254:255], v21 offset:2560
    ds_read_b64_tr_b16 v[240:241], v21 offset:4096
    ds_read_b64_tr_b16 v[242:243], v21 offset:4608
    ds_read_b64_tr_b16 v[244:245], v21 offset:6144
    ds_read_b64_tr_b16 v[246:247], v21 offset:6656
    ds_read_b64_tr_b16 v[236:237], v21 offset:8192
    ds_read_b64_tr_b16 v[238:239], v21 offset:8704
    s_waitcnt lgkmcnt(8)
    v_mfma_f32_32x32x16_bf16 v[192:207], v[32:35], v[248:251], 0
    ds_read_b64_tr_b16 v[232:233], v21 offset:10240
    ds_read_b64_tr_b16 v[234:235], v21 offset:10752
    s_nop 1
    v_cvt_pk_bf16_f32 v144, v144, v145
    v_cvt_pk_bf16_f32 v145, v146, v147
    s_waitcnt lgkmcnt(8)
    v_mfma_f32_32x32x16_bf16 v[192:207], v[36:39], v[252:255], v[192:207]
    ds_read_b64_tr_b16 v[248:249], v21 offset:12288
    ds_read_b64_tr_b16 v[250:251], v21 offset:12800
    v_cvt_pk_bf16_f32 v146, v148, v149
    v_cvt_pk_bf16_f32 v147, v150, v151
    v_cvt_pk_bf16_f32 v148, v152, v153
    s_waitcnt lgkmcnt(8)
    v_mfma_f32_32x32x16_bf16 v[192:207], v[40:43], v[240:243], v[192:207]
    ds_read_b64_tr_b16 v[252:253], v21 offset:14336
    ds_read_b64_tr_b16 v[254:255], v21 offset:14848
    v_cvt_pk_bf16_f32 v149, v154, v155
    v_cvt_pk_bf16_f32 v150, v156, v157
    v_cvt_pk_bf16_f32 v151, v158, v159
    s_waitcnt lgkmcnt(8)
    v_mfma_f32_32x32x16_bf16 v[192:207], v[44:47], v[244:247], v[192:207]
    ds_read_b64_tr_b16 v[240:241], v21 offset:16384
    ds_read_b64_tr_b16 v[242:243], v21 offset:16896
    buffer_store_dwordx4 v[144:147], v22, s[20:23], s50 offen offset:0 sc1
    buffer_store_dwordx4 v[148:151], v22, s[20:23], s51 offen offset:0 sc1
    v_cvt_pk_bf16_f32 v160, v160, v161
    s_waitcnt lgkmcnt(8)
    v_mfma_f32_32x32x16_bf16 v[192:207], v[48:51], v[236:239], v[192:207]
    ds_read_b64_tr_b16 v[244:245], v21 offset:18432
    ds_read_b64_tr_b16 v[246:247], v21 offset:18944
    v_cvt_pk_bf16_f32 v161, v162, v163
    v_cvt_pk_bf16_f32 v162, v164, v165
    v_cvt_pk_bf16_f32 v163, v166, v167
    s_waitcnt lgkmcnt(8)
    v_mfma_f32_32x32x16_bf16 v[192:207], v[52:55], v[232:235], v[192:207]
    ds_read_b64_tr_b16 v[236:237], v21 offset:20480
    ds_read_b64_tr_b16 v[238:239], v21 offset:20992
    v_cvt_pk_bf16_f32 v164, v168, v169
    v_cvt_pk_bf16_f32 v165, v170, v171
    v_cvt_pk_bf16_f32 v166, v172, v173
    s_waitcnt lgkmcnt(8)
    v_mfma_f32_32x32x16_bf16 v[192:207], v[56:59], v[248:251], v[192:207]
    ds_read_b64_tr_b16 v[232:233], v21 offset:22528
    ds_read_b64_tr_b16 v[234:235], v21 offset:23040
    v_cvt_pk_bf16_f32 v167, v174, v175
    buffer_store_dwordx4 v[160:163], v22, s[20:23], s50 offen offset:1024 sc1
    buffer_store_dwordx4 v[164:167], v22, s[20:23], s51 offen offset:1024 sc1
    s_waitcnt lgkmcnt(8)
    v_mfma_f32_32x32x16_bf16 v[192:207], v[60:63], v[252:255], v[192:207]
    ds_read_b64_tr_b16 v[248:249], v21 offset:24576
    ds_read_b64_tr_b16 v[250:251], v21 offset:25088
    v_cvt_pk_bf16_f32 v176, v176, v177
    v_cvt_pk_bf16_f32 v177, v178, v179
    v_cvt_pk_bf16_f32 v178, v180, v181
    s_waitcnt lgkmcnt(8)
    v_mfma_f32_32x32x16_bf16 v[192:207], v[64:67], v[240:243], v[192:207]
    ds_read_b64_tr_b16 v[252:253], v21 offset:26624
    ds_read_b64_tr_b16 v[254:255], v21 offset:27136
    v_cvt_pk_bf16_f32 v179, v182, v183
    v_cvt_pk_bf16_f32 v180, v184, v185
    v_cvt_pk_bf16_f32 v181, v186, v187
    s_waitcnt lgkmcnt(8)
    v_mfma_f32_32x32x16_bf16 v[192:207], v[68:71], v[244:247], v[192:207]
    ds_read_b64_tr_b16 v[240:241], v21 offset:28672
    ds_read_b64_tr_b16 v[242:243], v21 offset:29184
    v_cvt_pk_bf16_f32 v182, v188, v189
    v_cvt_pk_bf16_f32 v183, v190, v191
    buffer_store_dwordx4 v[176:179], v22, s[20:23], s50 offen offset:2048 sc1
    s_waitcnt lgkmcnt(8)
    v_mfma_f32_32x32x16_bf16 v[192:207], v[72:75], v[236:239], v[192:207]
    ds_read_b64_tr_b16 v[244:245], v21 offset:30720
    ds_read_b64_tr_b16 v[246:247], v21 offset:31232
    buffer_store_dwordx4 v[180:183], v22, s[20:23], s51 offen offset:2048 sc1
    s_waitcnt lgkmcnt(8)
    v_mfma_f32_32x32x16_bf16 v[192:207], v[76:79], v[232:235], v[192:207]
    v_subrev_u32 v21, 122880, v21
    ds_read_b64_tr_b16 v[236:237], v21 offset:0
    ds_read_b64_tr_b16 v[238:239], v21 offset:512
    s_waitcnt lgkmcnt(8)
    v_mfma_f32_32x32x16_bf16 v[192:207], v[80:83], v[248:251], v[192:207]
    ds_read_b64_tr_b16 v[232:233], v21 offset:2048
    ds_read_b64_tr_b16 v[234:235], v21 offset:2560
    s_waitcnt lgkmcnt(8)
    v_mfma_f32_32x32x16_bf16 v[192:207], v[84:87], v[252:255], v[192:207]
    ds_read_b64_tr_b16 v[248:249], v21 offset:4096
    ds_read_b64_tr_b16 v[250:251], v21 offset:4608
    s_waitcnt lgkmcnt(8)
    v_mfma_f32_32x32x16_bf16 v[192:207], v[88:91], v[240:243], v[192:207]
    ds_read_b64_tr_b16 v[252:253], v21 offset:6144
    ds_read_b64_tr_b16 v[254:255], v21 offset:6656
    s_waitcnt lgkmcnt(8)
    v_mfma_f32_32x32x16_bf16 v[192:207], v[92:95], v[244:247], v[192:207]
    ds_read_b64_tr_b16 v[240:241], v21 offset:8192
    ds_read_b64_tr_b16 v[242:243], v21 offset:8704
    s_waitcnt lgkmcnt(8)
    v_mfma_f32_32x32x16_bf16 v[192:207], v[96:99], v[236:239], v[192:207]
    ds_read_b64_tr_b16 v[244:245], v21 offset:10240
    ds_read_b64_tr_b16 v[246:247], v21 offset:10752
    s_waitcnt lgkmcnt(8)
    v_mfma_f32_32x32x16_bf16 v[192:207], v[100:103], v[232:235], v[192:207]
    ds_read_b64_tr_b16 v[236:237], v21 offset:12288
    ds_read_b64_tr_b16 v[238:239], v21 offset:12800
    s_waitcnt lgkmcnt(8)
    v_mfma_f32_32x32x16_bf16 v[192:207], v[104:107], v[248:251], v[192:207]
    ds_read_b64_tr_b16 v[232:233], v21 offset:14336
    ds_read_b64_tr_b16 v[234:235], v21 offset:14848
    s_waitcnt lgkmcnt(8)
    v_mfma_f32_32x32x16_bf16 v[192:207], v[108:111], v[252:255], v[192:207]
    ds_read_b64_tr_b16 v[248:249], v21 offset:16384
    ds_read_b64_tr_b16 v[250:251], v21 offset:16896
    s_waitcnt lgkmcnt(8)
    v_mfma_f32_32x32x16_bf16 v[192:207], v[112:115], v[240:243], v[192:207]
    ds_read_b64_tr_b16 v[252:253], v21 offset:18432
    ds_read_b64_tr_b16 v[254:255], v21 offset:18944
    s_waitcnt lgkmcnt(8)
    v_mfma_f32_32x32x16_bf16 v[192:207], v[116:119], v[244:247], v[192:207]
    ds_read_b64_tr_b16 v[240:241], v21 offset:20480
    ds_read_b64_tr_b16 v[242:243], v21 offset:20992
    s_waitcnt lgkmcnt(8)
    v_mfma_f32_32x32x16_bf16 v[192:207], v[120:123], v[236:239], v[192:207]
    ds_read_b64_tr_b16 v[244:245], v21 offset:22528
    ds_read_b64_tr_b16 v[246:247], v21 offset:23040
    s_waitcnt lgkmcnt(8)
    v_mfma_f32_32x32x16_bf16 v[192:207], v[124:127], v[232:235], v[192:207]
    s_waitcnt lgkmcnt(6)
    v_mfma_f32_32x32x16_bf16 v[192:207], v[128:131], v[248:251], v[192:207]
    s_waitcnt lgkmcnt(4)
    v_mfma_f32_32x32x16_bf16 v[192:207], v[132:135], v[252:255], v[192:207]
    s_waitcnt lgkmcnt(2)
    v_mfma_f32_32x32x16_bf16 v[192:207], v[136:139], v[240:243], v[192:207]
    s_waitcnt lgkmcnt(0)
    v_mfma_f32_32x32x16_bf16 v[192:207], v[140:143], v[244:247], v[192:207]
    s_mul_i32 s50, s49, 28672
    s_lshl_b32 s43, s37, 9
    s_add_u32 s50, s50, s43
    s_add_u32 s50, s50, 4190208
    s_add_u32 s51, s50, 14336
    s_nop 7
    v_cvt_pk_bf16_f32 v192, v192, v193
    v_cvt_pk_bf16_f32 v193, v194, v195
    v_cvt_pk_bf16_f32 v194, v196, v197
    v_cvt_pk_bf16_f32 v195, v198, v199
    v_cvt_pk_bf16_f32 v196, v200, v201
    v_cvt_pk_bf16_f32 v197, v202, v203
    v_cvt_pk_bf16_f32 v198, v204, v205
    v_cvt_pk_bf16_f32 v199, v206, v207
    buffer_store_dwordx4 v[192:195], v22, s[20:23], s50 offen offset:0 sc1
    buffer_store_dwordx4 v[196:199], v22, s[20:23], s51 offen offset:0 sc1
    s_waitcnt vmcnt(0)
    s_barrier
    s_cmp_lg_u32 s38, 3
    s_cbranch_scc1 k1_noflag_v
    s_mov_b32 s42, 16842752
    buffer_store_dword v13, v10, s[20:23], s42 offen sc1
    buffer_store_dword v13, v12, s[20:23], s65 offen sc1
k1_noflag_v:
    s_branch att_spin
k1_vg1:
    s_nop 7
    v_cvt_pk_bf16_f32 v144, v144, v145
    v_cvt_pk_bf16_f32 v145, v146, v147
    v_cvt_pk_bf16_f32 v146, v148, v149
    v_cvt_pk_bf16_f32 v147, v150, v151
    v_cvt_pk_bf16_f32 v148, v152, v153
    v_cvt_pk_bf16_f32 v149, v154, v155
    v_cvt_pk_bf16_f32 v150, v156, v157
    v_cvt_pk_bf16_f32 v151, v158, v159
    buffer_store_dwordx4 v[144:147], v22, s[20:23], s50 offen offset:0 sc1
    buffer_store_dwordx4 v[148:151], v22, s[20:23], s51 offen offset:0 sc1
    v_cvt_pk_bf16_f32 v160, v160, v161
    v_cvt_pk_bf16_f32 v161, v162, v163
    v_cvt_pk_bf16_f32 v162, v164, v165
    v_cvt_pk_bf16_f32 v163, v166, v167
    v_cvt_pk_bf16_f32 v164, v168, v169
    v_cvt_pk_bf16_f32 v165, v170, v171
    v_cvt_pk_bf16_f32 v166, v172, v173
    v_cvt_pk_bf16_f32 v167, v174, v175
    buffer_store_dwordx4 v[160:163], v22, s[20:23], s50 offen offset:1024 sc1
    buffer_store_dwordx4 v[164:167], v22, s[20:23], s51 offen offset:1024 sc1
    v_cvt_pk_bf16_f32 v176, v176, v177
    v_cvt_pk_bf16_f32 v177, v178, v179
    v_cvt_pk_bf16_f32 v178, v180, v181
    v_cvt_pk_bf16_f32 v179, v182, v183
    v_cvt_pk_bf16_f32 v180, v184, v185
    v_cvt_pk_bf16_f32 v181, v186, v187
    v_cvt_pk_bf16_f32 v182, v188, v189
    v_cvt_pk_bf16_f32 v183, v190, v191
    buffer_store_dwordx4 v[176:179], v22, s[20:23], s50 offen offset:2048 sc1
    buffer_store_dwordx4 v[180:183], v22, s[20:23], s51 offen offset:2048 sc1
    s_waitcnt vmcnt(0)
    s_barrier
    s_mov_b32 s51, 1073741824
    s_cmp_eq_u32 s37, 14
    s_cbranch_scc1 gemm_role
    ds_read_b128 v[248:251], v23 offset:0
    ds_read_b128 v[252:255], v23 offset:32
    ds_read_b128 v[240:243], v23 offset:64
    ds_read_b128 v[244:247], v23 offset:96
    ds_read_b128 v[236:239], v23 offset:128
    s_waitcnt lgkmcnt(4)
    v_mfma_f32_32x32x16_bf16 v[192:207], v[248:251], v[32:35], 0
    ds_read_b128 v[232:235], v23 offset:160
    s_waitcnt lgkmcnt(4)
    v_mfma_f32_32x32x16_bf16 v[192:207], v[252:255], v[36:39], v[192:207]
    ds_read_b128 v[248:251], v23 offset:192
    s_waitcnt lgkmcnt(4)
    v_mfma_f32_32x32x16_bf16 v[192:207], v[240:243], v[40:43], v[192:207]
    ds_read_b128 v[252:255], v23 offset:224
    s_waitcnt lgkmcnt(4)
    v_mfma_f32_32x32x16_bf16 v[192:207], v[244:247], v[44:47], v[192:207]
    ds_read_b128 v[240:243], v23 offset:256
    s_waitcnt lgkmcnt(4)
    v_mfma_f32_32x32x16_bf16 v[192:207], v[236:239], v[48:51], v[192:207]
    ds_read_b128 v[244:247], v23 offset:288
    s_waitcnt lgkmcnt(4)
    v_mfma_f32_32x32x16_bf16 v[192:207], v[232:235], v[52:55], v[192:207]
    ds_read_b128 v[236:239], v23 offset:320
    s_waitcnt lgkmcnt(4)
    v_mfma_f32_32x32x16_bf16 v[192:207], v[248:251], v[56:59], v[192:207]
    ds_read_b128 v[232:235], v23 offset:352
    s_waitcnt lgkmcnt(4)
    v_mfma_f32_32x32x16_bf16 v[192:207], v[252:255], v[60:63], v[192:207]
    ds_read_b128 v[248:251], v23 offset:384
    s_waitcnt lgkmcnt(4)
    v_mfma_f32_32x32x16_bf16 v[192:207], v[240:243], v[64:67], v[192:207]
    ds_read_b128 v[252:255], v23 offset:416
    s_waitcnt lgkmcnt(4)
    v_mfma_f32_32x32x16_bf16 v[192:207], v[244:247], v[68:71], v[192:207]
    ds_read_b128 v[240:243], v23 offset:448
    s_waitcnt lgkmcnt(4)
    v_mfma_f32_32x32x16_bf16 v[192:207], v[236:239], v[72:75], v[192:207]
    ds_read_b128 v[244:247], v23 offset:480
    s_waitcnt lgkmcnt(4)
    v_mfma_f32_32x32x16_bf16 v[192:207], v[232:235], v[76:79], v[192:207]
    ds_read_b128 v[236:239], v23 offset:512
    s_waitcnt lgkmcnt(4)
    v_mfma_f32_32x32x16_bf16 v[192:207], v[248:251], v[80:83], v[192:207]
    ds_read_b128 v[232:235], v23 offset:544
    s_waitcnt lgkmcnt(4)
    v_mfma_f32_32x32x16_bf16 v[192:207], v[252:255], v[84:87], v[192:207]
    ds_read_b128 v[248:251], v23 offset:576
    s_waitcnt lgkmcnt(4)
    v_mfma_f32_32x32x16_bf16 v[192:207], v[240:243], v[88:91], v[192:207]
    ds_read_b128 v[252:255], v23 offset:608
    s_waitcnt lgkmcnt(4)
    v_mfma_f32_32x32x16_bf16 v[192:207], v[244:247], v[92:95], v[192:207]
    ds_read_b128 v[240:243], v23 offset:640
    s_waitcnt lgkmcnt(4)
    v_mfma_f32_32x32x16_bf16 v[192:207], v[236:239], v[96:99], v[192:207]
    ds_read_b128 v[244:247], v23 offset:672
    s_waitcnt lgkmcnt(4)
    v_mfma_f32_32x32x16_bf16 v[192:207], v[232:235], v[100:103], v[192:207]
    ds_read_b128 v[236:239], v23 offset:704
    s_waitcnt lgkmcnt(4)
    v_mfma_f32_32x32x16_bf16 v[192:207], v[248:251], v[104:107], v[192:207]
    ds_read_b128 v[232:235], v23 offset:736
    s_waitcnt lgkmcnt(4)
    v_mfma_f32_32x32x16_bf16 v[192:207], v[252:255], v[108:111], v[192:207]
    ds_read_b128 v[248:251], v23 offset:768
    s_waitcnt lgkmcnt(4)
    v_mfma_f32_32x32x16_bf16 v[192:207], v[240:243], v[112:115], v[192:207]
    ds_read_b128 v[252:255], v23 offset:800
    s_waitcnt lgkmcnt(4)
    v_mfma_f32_32x32x16_bf16 v[192:207], v[244:247], v[116:119], v[192:207]
    ds_read_b128 v[240:243], v23 offset:832
    s_waitcnt lgkmcnt(4)
    v_mfma_f32_32x32x16_bf16 v[192:207], v[236:239], v[120:123], v[192:207]
    ds_read_b128 v[244:247], v23 offset:864
    s_waitcnt lgkmcnt(4)
    v_mfma_f32_32x32x16_bf16 v[192:207], v[232:235], v[124:127], v[192:207]
    s_waitcnt lgkmcnt(3)
    v_mfma_f32_32x32x16_bf16 v[192:207], v[248:251], v[128:131], v[192:207]
    s_waitcnt lgkmcnt(2)
    v_mfma_f32_32x32x16_bf16 v[192:207], v[252:255], v[132:135], v[192:207]
    s_waitcnt lgkmcnt(1)
    v_mfma_f32_32x32x16_bf16 v[192:207], v[240:243], v[136:139], v[192:207]
    s_waitcnt lgkmcnt(0)
    v_mfma_f32_32x32x16_bf16 v[192:207], v[244:247], v[140:143], v[192:207]
    s_nop 7
    s_nop 3
    v_mul_f32 v224, s60, v192
    v_exp_f32 v224, v224
    v_and_b32 v225, 31, v1
    v_add_f32 v224, 1.0, v224
    v_rcp_f32 v224, v224
    v_lshlrev_b32 v225, 2, v225
    s_lshl_b32 s42, s49, 7
    s_add_u32 s42, s42, 16777216
    buffer_store_dword v224, v225, s[20:23], s42 offen sc1
    s_waitcnt vmcnt(0)
gemm_role:
    s_add_u32 m0, s54, 98304
    s_add_u32 s42, s53, 0
    buffer_load_dwordx4 v31, s[28:31], s42 offen lds
    s_add_u32 m0, s54, 99328
    s_add_u32 s42, s42, 7168
    buffer_load_dwordx4 v31, s[28:31], s42 offen lds
    s_add_u32 m0, s54, 106496
    s_add_u32 s42, s53, 114688
    buffer_load_dwordx4 v31, s[28:31], s42 offen lds
    s_add_u32 m0, s54, 107520
    s_add_u32 s42, s42, 7168
    buffer_load_dwordx4 v31, s[28:31], s42 offen lds
    s_add_u32 m0, s54, 114688
    s_add_u32 s42, s53, 229376
    buffer_load_dwordx4 v31, s[28:31], s42 offen lds
    s_add_u32 m0, s54, 115712
    s_add_u32 s42, s42, 7168
    buffer_load_dwordx4 v31, s[28:31], s42 offen lds
    s_add_u32 m0, s54, 122880
    s_add_u32 s42, s53, 344064
    buffer_load_dwordx4 v31, s[28:31], s42 offen lds
    s_add_u32 m0, s54, 123904
    s_add_u32 s42, s42, 7168
    buffer_load_dwordx4 v31, s[28:31], s42 offen lds
    s_add_u32 m0, s54, 131072
    s_add_u32 s42, s53, 458752
    buffer_load_dwordx4 v31, s[28:31], s42 offen lds
    s_add_u32 m0, s54, 132096
    s_add_u32 s42, s42, 7168
    buffer_load_dwordx4 v31, s[28:31], s42 offen lds
    s_add_u32 m0, s54, 139264
    s_add_u32 s42, s53, 573440
    buffer_load_dwordx4 v31, s[28:31], s42 offen lds
    s_add_u32 m0, s54, 140288
    s_add_u32 s42, s42, 7168
    buffer_load_dwordx4 v31, s[28:31], s42 offen lds
    s_add_u32 m0, s54, 147456
    s_add_u32 s42, s53, 688128
    buffer_load_dwordx4 v31, s[28:31], s42 offen lds
    s_add_u32 m0, s54, 148480
    s_add_u32 s42, s42, 7168
    buffer_load_dwordx4 v31, s[28:31], s42 offen lds
gemm_role2:
    v_bfe_u32 v3, v1, 4, 1
    v_bfe_u32 v4, v1, 2, 2
    v_and_b32 v5, 2, v4
    v_xor_b32 v5, v5, v3
    s_and_b32 s42, s39, 1
    s_lshl_b32 s42, s42, 1
    v_xor_b32 v5, s42, v5
    v_lshrrev_b32 v6, 5, v1
    v_lshl_add_u32 v6, v6, 2, v4
    v_lshlrev_b32 v6, 7, v6
    v_lshl_add_u32 v6, v5, 5, v6
    v_and_b32 v5, 3, v1
    v_lshl_add_u32 v6, v5, 3, v6
    v_add_u32 v16, s54, v6
    v_xor_b32 v17, 64, v16
    v_add_u32 v18, 98304, v16
    v_add_u32 v19, 98304, v17
    v_mov_b32 v20, v6
    s_mov_b32 s8, s68
    s_mov_b32 s9, s69
    s_mov_b32 s10, 401408
    s_mov_b32 s11, 0x00020000
    s_mov_b32 s12, s80
    s_mov_b32 s13, s81
    s_mov_b32 s14, 1835008
    s_mov_b32 s15, 0x00020000
    s_lshr_b32 s48, s39, 1
    s_mul_i32 s42, s48, 114688
    v_add_u32 v21, s42, v2
    s_sub_u32 s42, 114688, s42
    v_add_u32 v22, s42, v2
    s_lshr_b32 s43, s41, 1
    s_lshl_b32 s43, s43, 9
    s_add_u32 s43, s43, 16908288
    s_lshl_b32 s47, s41, 10
    s_add_u32 s47, s47, 16941056
    s_mul_i32 s45, s41, 224
    s_add_u32 s45, s45, s39
    s_lshl_b32 s45, s45, 10
    s_add_u32 s45, s45, 6291456
    s_mul_i32 s46, s39, 100352
    s_lshl_b32 s42, s3, 7
    s_add_u32 s46, s46, s42
    v_and_b32 v25, 0x1ff, v7
    v_and_b32 v24, 0x3ff, v7
    s_add_u32 s44, s54, 32768
    v_add_u32 v26, s44, v2
    s_sub_u32 s50, s51, 2048
    s_cmp_lt_u32 s62, 28
    s_cbranch_scc1 gemm_has
    v_mov_b32 v3, 155684
lw3:
    ds_read_b32 v4, v3
    s_waitcnt lgkmcnt(0)
    v_readfirstlane_b32 s42, v4
    s_cmp_eq_u32 s42, 4
    s_cbranch_scc1 lwd3
    s_sleep 1
    s_branch lw3
lwd3:
    ds_read_b128 v[248:251], v26
    ds_read_b128 v[252:255], v26 offset:1024
    s_waitcnt lgkmcnt(0)
    buffer_store_dwordx4 v[240:243], v2, s[20:23], s51 offen offset:0 sc1
    buffer_store_dwordx4 v[244:247], v2, s[20:23], s51 offen offset:1024 sc1
    buffer_store_dwordx4 v[248:251], v2, s[20:23], s50 offen offset:0 sc1
    buffer_store_dwordx4 v[252:255], v2, s[20:23], s50 offen offset:1024 sc1
    s_waitcnt vmcnt(0)
    buffer_store_dword v13, v12, s[20:23], s55 offen sc1
    s_endpgm
gemm_has:
    s_cmp_lg_u32 s38, 4
    s_cbranch_scc1 g_noe
    v_mov_b32 v3, 155684
g_el:
    buffer_load_dword v23, v25, s[20:23], s43 offen sc1
    s_waitcnt vmcnt(0)
    v_cmp_ne_u32 vcc, s59, v23
    ds_read_b32 v4, v3
    s_cmp_eq_u64 vcc, 0
    s_cbranch_scc1 g_eok
    s_waitcnt lgkmcnt(0)
    v_readfirstlane_b32 s42, v4
    s_cmp_eq_u32 s42, 4
    s_cbranch_scc1 g_noe
    s_sleep 2
    s_branch g_el
g_eok:
    s_waitcnt lgkmcnt(0)
    v_mov_b32 v3, 155656
    v_mov_b32 v4, 1
    ds_write_b32 v3, v4
g_noe:
    v_mov_b32 v3, 155684
lw4:
    ds_read_b32 v4, v3
    s_waitcnt lgkmcnt(0)
    v_readfirstlane_b32 s42, v4
    s_cmp_eq_u32 s42, 4
    s_cbranch_scc1 lwd4
    s_sleep 1
    s_branch lw4
lwd4:
    ds_read_b128 v[248:251], v26
    ds_read_b128 v[252:255], v26 offset:1024
    s_waitcnt lgkmcnt(0)
    buffer_store_dwordx4 v[240:243], v2, s[20:23], s51 offen offset:0 sc1
    buffer_store_dwordx4 v[244:247], v2, s[20:23], s51 offen offset:1024 sc1
    buffer_store_dwordx4 v[248:251], v2, s[20:23], s50 offen offset:0 sc1
    buffer_store_dwordx4 v[252:255], v2, s[20:23], s50 offen offset:1024 sc1
    v_mov_b32 v3, 155656
    ds_read_b32 v4, v3
    s_waitcnt lgkmcnt(0)
    v_readfirstlane_b32 s42, v4
    s_cmp_eq_u32 s42, 1
    s_cbranch_scc1 gA_go
    s_cmp_lg_u32 s38, 4
    s_cbranch_scc1 gA_lw
    s_mov_b32 s63, 1048576
poll_ld5:
    buffer_load_dword v23, v25, s[20:23], s43 offen sc1
    s_waitcnt vmcnt(0)
    v_cmp_ne_u32 vcc, s59, v23
    s_sub_u32 s63, s63, 1
    s_cbranch_scc1 poll_done5
    s_cmp_eq_u64 vcc, 0
    s_cbranch_scc1 poll_done5
    s_sleep 8
    s_branch poll_ld5
poll_done5:
gA_ok:
    v_mov_b32 v3, 155656
    v_mov_b32 v4, 1
    ds_write_b32 v3, v4
    s_branch gA_go
gA_lw:
    v_mov_b32 v3, 155656
lw6:
    ds_read_b32 v4, v3
    s_waitcnt lgkmcnt(0)
    v_readfirstlane_b32 s42, v4
    s_cmp_eq_u32 s42, 1
    s_cbranch_scc1 lwd6
    s_sleep 2
    s_branch lw6
lwd6:
gA_go:
    s_add_u32 s42, s45, 0
    buffer_load_dwordx4 v[128:131], v21, s[20:23], s42 offen sc1
    buffer_load_dwordx4 v[132:135], v22, s[20:23], s42 offen sc1
    s_add_u32 s42, s45, 8192
    buffer_load_dwordx4 v[136:139], v21, s[20:23], s42 offen sc1
    buffer_load_dwordx4 v[140:143], v22, s[20:23], s42 offen sc1
    s_add_u32 s42, s45, 16384
    buffer_load_dwordx4 v[144:147], v21, s[20:23], s42 offen sc1
    buffer_load_dwordx4 v[148:151], v22, s[20:23], s42 offen sc1
    s_add_u32 s42, s45, 24576
    buffer_load_dwordx4 v[152:155], v21, s[20:23], s42 offen sc1
    buffer_load_dwordx4 v[156:159], v22, s[20:23], s42 offen sc1
    s_waitcnt vmcnt(18)
    ds_read_b64_tr_b16 v[32:33], v18 offset:0
    ds_read_b64_tr_b16 v[34:35], v18 offset:1024
    ds_read_b64_tr_b16 v[36:37], v19 offset:0
    ds_read_b64_tr_b16 v[38:39], v19 offset:1024
    s_waitcnt vmcnt(6) lgkmcnt(0)
    ds_read_b64_tr_b16 v[40:41], v18 offset:8192
    ds_read_b64_tr_b16 v[42:43], v18 offset:9216
    ds_read_b64_tr_b16 v[44:45], v19 offset:8192
    ds_read_b64_tr_b16 v[46:47], v19 offset:9216
    v_mfma_f32_32x32x16_bf16 v[64:79], v[32:35], v[128:131], 0
    v_mfma_f32_32x32x16_bf16 v[80:95], v[36:39], v[128:131], 0
    v_mfma_f32_32x32x16_bf16 v[96:111], v[32:35], v[132:135], 0
    v_mfma_f32_32x32x16_bf16 v[112:127], v[36:39], v[132:135], 0
    buffer_store_dword v13, v12, s[20:23], s55 offen sc1
    s_add_u32 s42, s45, 32768
    buffer_load_dwordx4 v[160:163], v21, s[20:23], s42 offen sc1
    buffer_load_dwordx4 v[164:167], v22, s[20:23], s42 offen sc1
    s_add_u32 m0, s54, 32768
    s_add_u32 s42, s53, 802816
    buffer_load_dwordx4 v31, s[28:31], s42 offen lds
    s_add_u32 m0, s54, 33792
    s_add_u32 s42, s42, 7168
    buffer_load_dwordx4 v31, s[28:31], s42 offen lds
    s_add_u32 s42, s45, 40960
    buffer_load_dwordx4 v[168:171], v21, s[20:23], s42 offen sc1
    buffer_load_dwordx4 v[172:175], v22, s[20:23], s42 offen sc1
    s_add_u32 m0, s54, 0
    s_add_u32 s42, s53, 917504
    buffer_load_dwordx4 v31, s[28:31], s42 offen lds
    s_add_u32 m0, s54, 1024
    s_add_u32 s42, s42, 7168
    buffer_load_dwordx4 v31, s[28:31], s42 offen lds
    s_waitcnt vmcnt(12) lgkmcnt(0)
    ds_read_b64_tr_b16 v[32:33], v18 offset:16384
    ds_read_b64_tr_b16 v[34:35], v18 offset:17408
    ds_read_b64_tr_b16 v[36:37], v19 offset:16384
    ds_read_b64_tr_b16 v[38:39], v19 offset:17408
    v_mfma_f32_32x32x16_bf16 v[64:79], v[40:43], v[136:139], v[64:79]
    v_mfma_f32_32x32x16_bf16 v[80:95], v[44:47], v[136:139], v[80:95]
    v_mfma_f32_32x32x16_bf16 v[96:111], v[40:43], v[140:143], v[96:111]
    v_mfma_f32_32x32x16_bf16 v[112:127], v[44:47], v[140:143], v[112:127]
    s_add_u32 s42, s45, 49152
    buffer_load_dwordx4 v[176:179], v21, s[20:23], s42 offen sc1
    buffer_load_dwordx4 v[180:183], v22, s[20:23], s42 offen sc1
    s_add_u32 m0, s54, 8192
    s_add_u32 s42, s53, 1032192
    buffer_load_dwordx4 v31, s[28:31], s42 offen lds
    s_add_u32 m0, s54, 9216
    s_add_u32 s42, s42, 7168
    buffer_load_dwordx4 v31, s[28:31], s42 offen lds
    s_add_u32 s42, s45, 57344
    buffer_load_dwordx4 v[184:187], v21, s[20:23], s42 offen sc1
    buffer_load_dwordx4 v[188:191], v22, s[20:23], s42 offen sc1
    s_add_u32 m0, s54, 16384
    s_add_u32 s42, s53, 1146880
    buffer_load_dwordx4 v31, s[28:31], s42 offen lds
    s_add_u32 m0, s54, 17408
    s_add_u32 s42, s42, 7168
    buffer_load_dwordx4 v31, s[28:31], s42 offen lds
    s_waitcnt vmcnt(18) lgkmcnt(0)
    ds_read_b64_tr_b16 v[40:41], v18 offset:24576
    ds_read_b64_tr_b16 v[42:43], v18 offset:25600
    ds_read_b64_tr_b16 v[44:45], v19 offset:24576
    ds_read_b64_tr_b16 v[46:47], v19 offset:25600
    v_mfma_f32_32x32x16_bf16 v[64:79], v[32:35], v[144:147], v[64:79]
    v_mfma_f32_32x32x16_bf16 v[80:95], v[36:39], v[144:147], v[80:95]
    v_mfma_f32_32x32x16_bf16 v[96:111], v[32:35], v[148:151], v[96:111]
    v_mfma_f32_32x32x16_bf16 v[112:127], v[36:39], v[148:151], v[112:127]
    s_add_u32 s42, s45, 65536
    buffer_load_dwordx4 v[192:195], v21, s[20:23], s42 offen sc1
    buffer_load_dwordx4 v[196:199], v22, s[20:23], s42 offen sc1
    s_add_u32 m0, s54, 24576
    s_add_u32 s42, s53, 1261568
    buffer_load_dwordx4 v31, s[28:31], s42 offen lds
    s_add_u32 m0, s54, 25600
    s_add_u32 s42, s42, 7168
    buffer_load_dwordx4 v31, s[28:31], s42 offen lds
    s_add_u32 s42, s45, 73728
    buffer_load_dwordx4 v[200:203], v21, s[20:23], s42 offen sc1
    buffer_load_dwordx4 v[204:207], v22, s[20:23], s42 offen sc1
    s_add_u32 m0, s54, 40960
    s_add_u32 s42, s53, 1376256
    buffer_load_dwordx4 v31, s[28:31], s42 offen lds
    s_add_u32 m0, s54, 41984
    s_add_u32 s42, s42, 7168
    buffer_load_dwordx4 v31, s[28:31], s42 offen lds
    s_waitcnt vmcnt(24) lgkmcnt(0)
    ds_read_b64_tr_b16 v[32:33], v18 offset:32768
    ds_read_b64_tr_b16 v[34:35], v18 offset:33792
    ds_read_b64_tr_b16 v[36:37], v19 offset:32768
    ds_read_b64_tr_b16 v[38:39], v19 offset:33792
    v_mfma_f32_32x32x16_bf16 v[64:79], v[40:43], v[152:155], v[64:79]
    v_mfma_f32_32x32x16_bf16 v[80:95], v[44:47], v[152:155], v[80:95]
    v_mfma_f32_32x32x16_bf16 v[96:111], v[40:43], v[156:159], v[96:111]
    v_mfma_f32_32x32x16_bf16 v[112:127], v[44:47], v[156:159], v[112:127]
    s_add_u32 s42, s45, 81920
    buffer_load_dwordx4 v[128:131], v21, s[20:23], s42 offen sc1
    buffer_load_dwordx4 v[132:135], v22, s[20:23], s42 offen sc1
    s_add_u32 m0, s54, 98304
    s_add_u32 s42, s53, 1490944
    buffer_load_dwordx4 v31, s[28:31], s42 offen lds
    s_add_u32 m0, s54, 99328
    s_add_u32 s42, s42, 7168
    buffer_load_dwordx4 v31, s[28:31], s42 offen lds
    s_add_u32 s42, s45, 90112
    buffer_load_dwordx4 v[136:139], v21, s[20:23], s42 offen sc1
    buffer_load_dwordx4 v[140:143], v22, s[20:23], s42 offen sc1
    s_add_u32 m0, s54, 106496
    s_add_u32 s42, s53, 57344
    buffer_load_dwordx4 v31, s[28:31], s42 offen lds
    s_add_u32 m0, s54, 107520
    s_add_u32 s42, s42, 7168
    buffer_load_dwordx4 v31, s[28:31], s42 offen lds
    s_waitcnt vmcnt(30) lgkmcnt(0)
    ds_read_b64_tr_b16 v[40:41], v18 offset:40960
    ds_read_b64_tr_b16 v[42:43], v18 offset:41984
    ds_read_b64_tr_b16 v[44:45], v19 offset:40960
    ds_read_b64_tr_b16 v[46:47], v19 offset:41984
    v_mfma_f32_32x32x16_bf16 v[64:79], v[32:35], v[160:163], v[64:79]
    v_mfma_f32_32x32x16_bf16 v[80:95], v[36:39], v[160:163], v[80:95]
    v_mfma_f32_32x32x16_bf16 v[96:111], v[32:35], v[164:167], v[96:111]
    v_mfma_f32_32x32x16_bf16 v[112:127], v[36:39], v[164:167], v[112:127]
    s_add_u32 s42, s45, 98304
    buffer_load_dwordx4 v[144:147], v21, s[20:23], s42 offen sc1
    buffer_load_dwordx4 v[148:151], v22, s[20:23], s42 offen sc1
    s_add_u32 m0, s54, 114688
    s_add_u32 s42, s53, 172032
    buffer_load_dwordx4 v31, s[28:31], s42 offen lds
    s_add_u32 m0, s54, 115712
    s_add_u32 s42, s42, 7168
    buffer_load_dwordx4 v31, s[28:31], s42 offen lds
    s_add_u32 s42, s45, 106496
    buffer_load_dwordx4 v[152:155], v21, s[20:23], s42 offen sc1
    buffer_load_dwordx4 v[156:159], v22, s[20:23], s42 offen sc1
    s_waitcnt vmcnt(32) lgkmcnt(0)
    ds_read_b64_tr_b16 v[32:33], v18 offset:49152
    ds_read_b64_tr_b16 v[34:35], v18 offset:50176
    ds_read_b64_tr_b16 v[36:37], v19 offset:49152
    ds_read_b64_tr_b16 v[38:39], v19 offset:50176
    v_mfma_f32_32x32x16_bf16 v[64:79], v[40:43], v[168:171], v[64:79]
    v_mfma_f32_32x32x16_bf16 v[80:95], v[44:47], v[168:171], v[80:95]
    v_mfma_f32_32x32x16_bf16 v[96:111], v[40:43], v[172:175], v[96:111]
    v_mfma_f32_32x32x16_bf16 v[112:127], v[44:47], v[172:175], v[112:127]
    s_add_u32 m0, s54, 122880
    s_add_u32 s42, s53, 286720
    buffer_load_dwordx4 v31, s[28:31], s42 offen lds
    s_add_u32 m0, s54, 123904
    s_add_u32 s42, s42, 7168
    buffer_load_dwordx4 v31, s[28:31], s42 offen lds
    s_waitcnt vmcnt(30) lgkmcnt(0)
    ds_read_b64_tr_b16 v[40:41], v16 offset:32768
    ds_read_b64_tr_b16 v[42:43], v16 offset:33792
    ds_read_b64_tr_b16 v[44:45], v17 offset:32768
    ds_read_b64_tr_b16 v[46:47], v17 offset:33792
    v_mfma_f32_32x32x16_bf16 v[64:79], v[32:35], v[176:179], v[64:79]
    v_mfma_f32_32x32x16_bf16 v[80:95], v[36:39], v[176:179], v[80:95]
    v_mfma_f32_32x32x16_bf16 v[96:111], v[32:35], v[180:183], v[96:111]
    v_mfma_f32_32x32x16_bf16 v[112:127], v[36:39], v[180:183], v[112:127]
    s_add_u32 m0, s54, 131072
    s_add_u32 s42, s53, 401408
    buffer_load_dwordx4 v31, s[28:31], s42 offen lds
    s_add_u32 m0, s54, 132096
    s_add_u32 s42, s42, 7168
    buffer_load_dwordx4 v31, s[28:31], s42 offen lds
    s_waitcnt vmcnt(28) lgkmcnt(0)
    ds_read_b64_tr_b16 v[32:33], v16 offset:0
    ds_read_b64_tr_b16 v[34:35], v16 offset:1024
    ds_read_b64_tr_b16 v[36:37], v17 offset:0
    ds_read_b64_tr_b16 v[38:39], v17 offset:1024
    v_mfma_f32_32x32x16_bf16 v[64:79], v[40:43], v[184:187], v[64:79]
    v_mfma_f32_32x32x16_bf16 v[80:95], v[44:47], v[184:187], v[80:95]
    v_mfma_f32_32x32x16_bf16 v[96:111], v[40:43], v[188:191], v[96:111]
    v_mfma_f32_32x32x16_bf16 v[112:127], v[44:47], v[188:191], v[112:127]
    s_cmp_lg_u32 s38, 4
    s_cbranch_scc1 gB_lw
    s_mov_b32 s63, 1048576
poll_ld7:
    buffer_load_dword v9, v24, s[20:23], s47 offen sc1
    s_waitcnt vmcnt(0)
    v_cmp_ne_u32 vcc, s59, v9
    s_sub_u32 s63, s63, 1
    s_cbranch_scc1 poll_done7
    s_cmp_eq_u64 vcc, 0
    s_cbranch_scc1 poll_done7
    s_sleep 8
    s_branch poll_ld7
poll_done7:
gB_ok:
    v_mov_b32 v3, 155660
    v_mov_b32 v4, 1
    ds_write_b32 v3, v4
    s_branch gB_go
gB_lw:
    v_mov_b32 v3, 155660
lw8:
    ds_read_b32 v4, v3
    s_waitcnt lgkmcnt(0)
    v_readfirstlane_b32 s42, v4
    s_cmp_eq_u32 s42, 1
    s_cbranch_scc1 lwd8
    s_sleep 2
    s_branch lw8
lwd8:
gB_go:
    v_and_b32 v3, 31, v1
    v_lshlrev_b32 v3, 2, v3
    s_lshl_b32 s43, s41, 1
    s_add_u32 s43, s43, s48
    s_lshl_b32 s43, s43, 7
    s_add_u32 s43, s43, 16777216
    buffer_load_dword v23, v3, s[20:23], s43 offen sc1
    s_add_u32 s42, s45, 4096
    buffer_load_dwordx4 v[160:163], v21, s[20:23], s42 offen sc1
    buffer_load_dwordx4 v[164:167], v22, s[20:23], s42 offen sc1
    s_add_u32 m0, s54, 139264
    s_add_u32 s42, s53, 516096
    buffer_load_dwordx4 v31, s[28:31], s42 offen lds
    s_add_u32 m0, s54, 140288
    s_add_u32 s42, s42, 7168
    buffer_load_dwordx4 v31, s[28:31], s42 offen lds
    s_add_u32 s42, s45, 12288
    buffer_load_dwordx4 v[168:171], v21, s[20:23], s42 offen sc1
    buffer_load_dwordx4 v[172:175], v22, s[20:23], s42 offen sc1
    s_waitcnt vmcnt(31) lgkmcnt(0)
    ds_read_b64_tr_b16 v[40:41], v16 offset:8192
    ds_read_b64_tr_b16 v[42:43], v16 offset:9216
    ds_read_b64_tr_b16 v[44:45], v17 offset:8192
    ds_read_b64_tr_b16 v[46:47], v17 offset:9216
    v_mfma_f32_32x32x16_bf16 v[64:79], v[32:35], v[192:195], v[64:79]
    v_mfma_f32_32x32x16_bf16 v[80:95], v[36:39], v[192:195], v[80:95]
    v_mfma_f32_32x32x16_bf16 v[96:111], v[32:35], v[196:199], v[96:111]
    v_mfma_f32_32x32x16_bf16 v[112:127], v[36:39], v[196:199], v[112:127]
    s_add_u32 s42, s45, 20480
    buffer_load_dwordx4 v[176:179], v21, s[20:23], s42 offen sc1
    buffer_load_dwordx4 v[180:183], v22, s[20:23], s42 offen sc1
    s_add_u32 m0, s54, 147456
    s_add_u32 s42, s53, 630784
    buffer_load_dwordx4 v31, s[28:31], s42 offen lds
    s_add_u32 m0, s54, 148480
    s_add_u32 s42, s42, 7168
    buffer_load_dwordx4 v31, s[28:31], s42 offen lds
    s_add_u32 s42, s45, 28672
    buffer_load_dwordx4 v[184:187], v21, s[20:23], s42 offen sc1
    buffer_load_dwordx4 v[188:191], v22, s[20:23], s42 offen sc1
    s_waitcnt vmcnt(33) lgkmcnt(0)
    ds_read_b64_tr_b16 v[32:33], v16 offset:16384
    ds_read_b64_tr_b16 v[34:35], v16 offset:17408
    ds_read_b64_tr_b16 v[36:37], v17 offset:16384
    ds_read_b64_tr_b16 v[38:39], v17 offset:17408
    v_mfma_f32_32x32x16_bf16 v[64:79], v[40:43], v[200:203], v[64:79]
    v_mfma_f32_32x32x16_bf16 v[80:95], v[44:47], v[200:203], v[80:95]
    v_mfma_f32_32x32x16_bf16 v[96:111], v[40:43], v[204:207], v[96:111]
    v_mfma_f32_32x32x16_bf16 v[112:127], v[44:47], v[204:207], v[112:127]
    s_add_u32 s42, s45, 36864
    buffer_load_dwordx4 v[192:195], v21, s[20:23], s42 offen sc1
    buffer_load_dwordx4 v[196:199], v22, s[20:23], s42 offen sc1
    s_add_u32 m0, s54, 32768
    s_add_u32 s42, s53, 745472
    buffer_load_dwordx4 v31, s[28:31], s42 offen lds
    s_add_u32 m0, s54, 33792
    s_add_u32 s42, s42, 7168
    buffer_load_dwordx4 v31, s[28:31], s42 offen lds
    s_add_u32 s42, s45, 45056
    buffer_load_dwordx4 v[200:203], v21, s[20:23], s42 offen sc1
    buffer_load_dwordx4 v[204:207], v22, s[20:23], s42 offen sc1
    s_waitcnt vmcnt(35) lgkmcnt(0)
    ds_read_b64_tr_b16 v[40:41], v16 offset:24576
    ds_read_b64_tr_b16 v[42:43], v16 offset:25600
    ds_read_b64_tr_b16 v[44:45], v17 offset:24576
    ds_read_b64_tr_b16 v[46:47], v17 offset:25600
    v_mfma_f32_32x32x16_bf16 v[64:79], v[32:35], v[128:131], v[64:79]
    v_mfma_f32_32x32x16_bf16 v[80:95], v[36:39], v[128:131], v[80:95]
    v_mfma_f32_32x32x16_bf16 v[96:111], v[32:35], v[132:135], v[96:111]
    v_mfma_f32_32x32x16_bf16 v[112:127], v[36:39], v[132:135], v[112:127]
    s_add_u32 s42, s45, 53248
    buffer_load_dwordx4 v[128:131], v21, s[20:23], s42 offen sc1
    buffer_load_dwordx4 v[132:135], v22, s[20:23], s42 offen sc1
    s_add_u32 m0, s54, 0
    s_add_u32 s42, s53, 860160
    buffer_load_dwordx4 v31, s[28:31], s42 offen lds
    s_add_u32 m0, s54, 1024
    s_add_u32 s42, s42, 7168
    buffer_load_dwordx4 v31, s[28:31], s42 offen lds
    s_waitcnt vmcnt(35) lgkmcnt(0)
    ds_read_b64_tr_b16 v[32:33], v16 offset:40960
    ds_read_b64_tr_b16 v[34:35], v16 offset:41984
    ds_read_b64_tr_b16 v[36:37], v17 offset:40960
    ds_read_b64_tr_b16 v[38:39], v17 offset:41984
    v_mfma_f32_32x32x16_bf16 v[64:79], v[40:43], v[136:139], v[64:79]
    v_mfma_f32_32x32x16_bf16 v[80:95], v[44:47], v[136:139], v[80:95]
    v_mfma_f32_32x32x16_bf16 v[96:111], v[40:43], v[140:143], v[96:111]
    v_mfma_f32_32x32x16_bf16 v[112:127], v[44:47], v[140:143], v[112:127]
    s_add_u32 s42, s45, 61440
    buffer_load_dwordx4 v[136:139], v21, s[20:23], s42 offen sc1
    buffer_load_dwordx4 v[140:143], v22, s[20:23], s42 offen sc1
    s_add_u32 m0, s54, 8192
    s_add_u32 s42, s53, 974848
    buffer_load_dwordx4 v31, s[28:31], s42 offen lds
    s_add_u32 m0, s54, 9216
    s_add_u32 s42, s42, 7168
    buffer_load_dwordx4 v31, s[28:31], s42 offen lds
    s_waitcnt vmcnt(35) lgkmcnt(0)
    ds_read_b64_tr_b16 v[40:41], v18 offset:0
    ds_read_b64_tr_b16 v[42:43], v18 offset:1024
    ds_read_b64_tr_b16 v[44:45], v19 offset:0
    ds_read_b64_tr_b16 v[46:47], v19 offset:1024
    v_mfma_f32_32x32x16_bf16 v[64:79], v[32:35], v[144:147], v[64:79]
    v_mfma_f32_32x32x16_bf16 v[80:95], v[36:39], v[144:147], v[80:95]
    v_mfma_f32_32x32x16_bf16 v[96:111], v[32:35], v[148:151], v[96:111]
    v_mfma_f32_32x32x16_bf16 v[112:127], v[36:39], v[148:151], v[112:127]
    s_add_u32 s42, s45, 69632
    buffer_load_dwordx4 v[144:147], v21, s[20:23], s42 offen sc1
    buffer_load_dwordx4 v[148:151], v22, s[20:23], s42 offen sc1
    s_add_u32 m0, s54, 16384
    s_add_u32 s42, s53, 1089536
    buffer_load_dwordx4 v31, s[28:31], s42 offen lds
    s_add_u32 m0, s54, 17408
    s_add_u32 s42, s42, 7168
    buffer_load_dwordx4 v31, s[28:31], s42 offen lds
    s_waitcnt vmcnt(35) lgkmcnt(0)
    ds_read_b64_tr_b16 v[32:33], v18 offset:8192
    ds_read_b64_tr_b16 v[34:35], v18 offset:9216
    ds_read_b64_tr_b16 v[36:37], v19 offset:8192
    ds_read_b64_tr_b16 v[38:39], v19 offset:9216
    v_mfma_f32_32x32x16_bf16 v[64:79], v[40:43], v[152:155], v[64:79]
    v_mfma_f32_32x32x16_bf16 v[80:95], v[44:47], v[152:155], v[80:95]
    v_mfma_f32_32x32x16_bf16 v[96:111], v[40:43], v[156:159], v[96:111]
    v_mfma_f32_32x32x16_bf16 v[112:127], v[44:47], v[156:159], v[112:127]
    s_add_u32 s42, s45, 77824
    buffer_load_dwordx4 v[152:155], v21, s[20:23], s42 offen sc1
    buffer_load_dwordx4 v[156:159], v22, s[20:23], s42 offen sc1
    s_add_u32 m0, s54, 24576
    s_add_u32 s42, s53, 1204224
    buffer_load_dwordx4 v31, s[28:31], s42 offen lds
    s_add_u32 m0, s54, 25600
    s_add_u32 s42, s42, 7168
    buffer_load_dwordx4 v31, s[28:31], s42 offen lds
    s_waitcnt vmcnt(32) lgkmcnt(0)
    ds_read_b64_tr_b16 v[40:41], v18 offset:16384
    ds_read_b64_tr_b16 v[42:43], v18 offset:17408
    ds_read_b64_tr_b16 v[44:45], v19 offset:16384
    ds_read_b64_tr_b16 v[46:47], v19 offset:17408
    v_mfma_f32_32x32x16_bf16 v[64:79], v[32:35], v[160:163], v[64:79]
    v_mfma_f32_32x32x16_bf16 v[80:95], v[36:39], v[160:163], v[80:95]
    v_mfma_f32_32x32x16_bf16 v[96:111], v[32:35], v[164:167], v[96:111]
    v_mfma_f32_32x32x16_bf16 v[112:127], v[36:39], v[164:167], v[112:127]
    s_add_u32 s42, s45, 86016
    buffer_load_dwordx4 v[160:163], v21, s[20:23], s42 offen sc1
    buffer_load_dwordx4 v[164:167], v22, s[20:23], s42 offen sc1
    s_add_u32 m0, s54, 40960
    s_add_u32 s42, s53, 1318912
    buffer_load_dwordx4 v31, s[28:31], s42 offen lds
    s_add_u32 m0, s54, 41984
    s_add_u32 s42, s42, 7168
    buffer_load_dwordx4 v31, s[28:31], s42 offen lds
    s_waitcnt vmcnt(32) lgkmcnt(0)
    ds_read_b64_tr_b16 v[32:33], v18 offset:24576
    ds_read_b64_tr_b16 v[34:35], v18 offset:25600
    ds_read_b64_tr_b16 v[36:37], v19 offset:24576
    ds_read_b64_tr_b16 v[38:39], v19 offset:25600
    v_mfma_f32_32x32x16_bf16 v[64:79], v[40:43], v[168:171], v[64:79]
    v_mfma_f32_32x32x16_bf16 v[80:95], v[44:47], v[168:171], v[80:95]
    v_mfma_f32_32x32x16_bf16 v[96:111], v[40:43], v[172:175], v[96:111]
    v_mfma_f32_32x32x16_bf16 v[112:127], v[44:47], v[172:175], v[112:127]
    s_add_u32 s42, s45, 94208
    buffer_load_dwordx4 v[168:171], v21, s[20:23], s42 offen sc1
    buffer_load_dwordx4 v[172:175], v22, s[20:23], s42 offen sc1
    s_add_u32 m0, s54, 98304
    s_add_u32 s42, s53, 1433600
    buffer_load_dwordx4 v31, s[28:31], s42 offen lds
    s_add_u32 m0, s54, 99328
    s_add_u32 s42, s42, 7168
    buffer_load_dwordx4 v31, s[28:31], s42 offen lds
    s_waitcnt vmcnt(34) lgkmcnt(0)
    ds_read_b64_tr_b16 v[40:41], v18 offset:32768
    ds_read_b64_tr_b16 v[42:43], v18 offset:33792
    ds_read_b64_tr_b16 v[44:45], v19 offset:32768
    ds_read_b64_tr_b16 v[46:47], v19 offset:33792
    v_mfma_f32_32x32x16_bf16 v[64:79], v[32:35], v[176:179], v[64:79]
    v_mfma_f32_32x32x16_bf16 v[80:95], v[36:39], v[176:179], v[80:95]
    v_mfma_f32_32x32x16_bf16 v[96:111], v[32:35], v[180:183], v[96:111]
    v_mfma_f32_32x32x16_bf16 v[112:127], v[36:39], v[180:183], v[112:127]
    s_add_u32 s42, s45, 102400
    buffer_load_dwordx4 v[176:179], v21, s[20:23], s42 offen sc1
    buffer_load_dwordx4 v[180:183], v22, s[20:23], s42 offen sc1
    s_add_u32 m0, s54, 106496
    s_add_u32 s42, s53, 1548288
    buffer_load_dwordx4 v31, s[28:31], s42 offen lds
    s_add_u32 m0, s54, 107520
    s_add_u32 s42, s42, 7168
    buffer_load_dwordx4 v31, s[28:31], s42 offen lds
    s_waitcnt vmcnt(34) lgkmcnt(0)
    ds_read_b64_tr_b16 v[32:33], v18 offset:40960
    ds_read_b64_tr_b16 v[34:35], v18 offset:41984
    ds_read_b64_tr_b16 v[36:37], v19 offset:40960
    ds_read_b64_tr_b16 v[38:39], v19 offset:41984
    v_mfma_f32_32x32x16_bf16 v[64:79], v[40:43], v[184:187], v[64:79]
    v_mfma_f32_32x32x16_bf16 v[80:95], v[44:47], v[184:187], v[80:95]
    v_mfma_f32_32x32x16_bf16 v[96:111], v[40:43], v[188:191], v[96:111]
    v_mfma_f32_32x32x16_bf16 v[112:127], v[44:47], v[188:191], v[112:127]
    s_add_u32 s42, s45, 110592
    buffer_load_dwordx4 v[184:187], v21, s[20:23], s42 offen sc1
    buffer_load_dwordx4 v[188:191], v22, s[20:23], s42 offen sc1
    s_add_u32 m0, s54, 114688
    s_add_u32 s42, s46, 0
    buffer_load_dwordx4 v31, s[8:11], s42 offen lds
    s_add_u32 m0, s54, 115712
    s_add_u32 s42, s42, 7168
    buffer_load_dwordx4 v31, s[8:11], s42 offen lds
    s_waitcnt vmcnt(36) lgkmcnt(0)
    ds_read_b64_tr_b16 v[40:41], v18 offset:49152
    ds_read_b64_tr_b16 v[42:43], v18 offset:50176
    ds_read_b64_tr_b16 v[44:45], v19 offset:49152
    ds_read_b64_tr_b16 v[46:47], v19 offset:50176
    v_mfma_f32_32x32x16_bf16 v[64:79], v[32:35], v[192:195], v[64:79]
    v_mfma_f32_32x32x16_bf16 v[80:95], v[36:39], v[192:195], v[80:95]
    v_mfma_f32_32x32x16_bf16 v[96:111], v[32:35], v[196:199], v[96:111]
    v_mfma_f32_32x32x16_bf16 v[112:127], v[36:39], v[196:199], v[112:127]
    s_add_u32 m0, s54, 122880
    s_add_u32 s42, s46, 14336
    buffer_load_dwordx4 v31, s[8:11], s42 offen lds
    s_add_u32 m0, s54, 123904
    s_add_u32 s42, s42, 7168
    buffer_load_dwordx4 v31, s[8:11], s42 offen lds
    s_waitcnt vmcnt(34) lgkmcnt(0)
    ds_read_b64_tr_b16 v[32:33], v16 offset:32768
    ds_read_b64_tr_b16 v[34:35], v16 offset:33792
    ds_read_b64_tr_b16 v[36:37], v17 offset:32768
    ds_read_b64_tr_b16 v[38:39], v17 offset:33792
    v_mfma_f32_32x32x16_bf16 v[64:79], v[40:43], v[200:203], v[64:79]
    v_mfma_f32_32x32x16_bf16 v[80:95], v[44:47], v[200:203], v[80:95]
    v_mfma_f32_32x32x16_bf16 v[96:111], v[40:43], v[204:207], v[96:111]
    v_mfma_f32_32x32x16_bf16 v[112:127], v[44:47], v[204:207], v[112:127]
    s_add_u32 m0, s54, 131072
    s_add_u32 s42, s46, 25088
    buffer_load_dwordx4 v31, s[8:11], s42 offen lds
    s_add_u32 m0, s54, 132096
    s_add_u32 s42, s42, 7168
    buffer_load_dwordx4 v31, s[8:11], s42 offen lds
    s_waitcnt vmcnt(32) lgkmcnt(0)
    ds_read_b64_tr_b16 v[40:41], v16 offset:0
    ds_read_b64_tr_b16 v[42:43], v16 offset:1024
    ds_read_b64_tr_b16 v[44:45], v17 offset:0
    ds_read_b64_tr_b16 v[46:47], v17 offset:1024
    v_mfma_f32_32x32x16_bf16 v[64:79], v[32:35], v[128:131], v[64:79]
    v_mfma_f32_32x32x16_bf16 v[80:95], v[36:39], v[128:131], v[80:95]
    v_mfma_f32_32x32x16_bf16 v[96:111], v[32:35], v[132:135], v[96:111]
    v_mfma_f32_32x32x16_bf16 v[112:127], v[36:39], v[132:135], v[112:127]
    s_add_u32 m0, s54, 139264
    s_add_u32 s42, s46, 39424
    buffer_load_dwordx4 v31, s[8:11], s42 offen lds
    s_add_u32 m0, s54, 140288
    s_add_u32 s42, s42, 7168
    buffer_load_dwordx4 v31, s[8:11], s42 offen lds
    s_waitcnt vmcnt(30) lgkmcnt(0)
    ds_read_b64_tr_b16 v[32:33], v16 offset:8192
    ds_read_b64_tr_b16 v[34:35], v16 offset:9216
    ds_read_b64_tr_b16 v[36:37], v17 offset:8192
    ds_read_b64_tr_b16 v[38:39], v17 offset:9216
    v_mfma_f32_32x32x16_bf16 v[64:79], v[40:43], v[136:139], v[64:79]
    v_mfma_f32_32x32x16_bf16 v[80:95], v[44:47], v[136:139], v[80:95]
    v_mfma_f32_32x32x16_bf16 v[96:111], v[40:43], v[140:143], v[96:111]
    v_mfma_f32_32x32x16_bf16 v[112:127], v[44:47], v[140:143], v[112:127]
    s_add_u32 m0, s54, 0
    s_add_u32 s42, s46, 50176
    buffer_load_dwordx4 v31, s[8:11], s42 offen lds
    s_add_u32 m0, s54, 1024
    s_add_u32 s42, s42, 7168
    buffer_load_dwordx4 v31, s[8:11], s42 offen lds
    s_waitcnt vmcnt(28) lgkmcnt(0)
    ds_read_b64_tr_b16 v[40:41], v16 offset:16384
    ds_read_b64_tr_b16 v[42:43], v16 offset:17408
    ds_read_b64_tr_b16 v[44:45], v17 offset:16384
    ds_read_b64_tr_b16 v[46:47], v17 offset:17408
    v_mfma_f32_32x32x16_bf16 v[64:79], v[32:35], v[144:147], v[64:79]
    v_mfma_f32_32x32x16_bf16 v[80:95], v[36:39], v[144:147], v[80:95]
    v_mfma_f32_32x32x16_bf16 v[96:111], v[32:35], v[148:151], v[96:111]
    v_mfma_f32_32x32x16_bf16 v[112:127], v[36:39], v[148:151], v[112:127]
    s_add_u32 m0, s54, 8192
    s_add_u32 s42, s46, 64512
    buffer_load_dwordx4 v31, s[8:11], s42 offen lds
    s_add_u32 m0, s54, 9216
    s_add_u32 s42, s42, 7168
    buffer_load_dwordx4 v31, s[8:11], s42 offen lds
    s_waitcnt vmcnt(26) lgkmcnt(0)
    ds_read_b64_tr_b16 v[32:33], v16 offset:24576
    ds_read_b64_tr_b16 v[34:35], v16 offset:25600
    ds_read_b64_tr_b16 v[36:37], v17 offset:24576
    ds_read_b64_tr_b16 v[38:39], v17 offset:25600
    v_mfma_f32_32x32x16_bf16 v[64:79], v[40:43], v[152:155], v[64:79]
    v_mfma_f32_32x32x16_bf16 v[80:95], v[44:47], v[152:155], v[80:95]
    v_mfma_f32_32x32x16_bf16 v[96:111], v[40:43], v[156:159], v[96:111]
    v_mfma_f32_32x32x16_bf16 v[112:127], v[44:47], v[156:159], v[112:127]
    s_add_u32 m0, s54, 16384
    s_add_u32 s42, s46, 75264
    buffer_load_dwordx4 v31, s[8:11], s42 offen lds
    s_add_u32 m0, s54, 17408
    s_add_u32 s42, s42, 7168
    buffer_load_dwordx4 v31, s[8:11], s42 offen lds
    s_waitcnt vmcnt(24) lgkmcnt(0)
    ds_read_b64_tr_b16 v[40:41], v16 offset:40960
    ds_read_b64_tr_b16 v[42:43], v16 offset:41984
    ds_read_b64_tr_b16 v[44:45], v17 offset:40960
    ds_read_b64_tr_b16 v[46:47], v17 offset:41984
    v_mfma_f32_32x32x16_bf16 v[64:79], v[32:35], v[160:163], v[64:79]
    v_mfma_f32_32x32x16_bf16 v[80:95], v[36:39], v[160:163], v[80:95]
    v_mfma_f32_32x32x16_bf16 v[96:111], v[32:35], v[164:167], v[96:111]
    v_mfma_f32_32x32x16_bf16 v[112:127], v[36:39], v[164:167], v[112:127]
    s_add_u32 m0, s54, 24576
    s_add_u32 s42, s46, 89600
    buffer_load_dwordx4 v31, s[8:11], s42 offen lds
    s_add_u32 m0, s54, 25600
    s_add_u32 s42, s42, 7168
    buffer_load_dwordx4 v31, s[8:11], s42 offen lds
    s_waitcnt vmcnt(22) lgkmcnt(0)
    ds_read_b64_tr_b16 v[32:33], v18 offset:0
    ds_read_b64_tr_b16 v[34:35], v18 offset:1024
    ds_read_b64_tr_b16 v[36:37], v19 offset:0
    ds_read_b64_tr_b16 v[38:39], v19 offset:1024
    v_mfma_f32_32x32x16_bf16 v[64:79], v[40:43], v[168:171], v[64:79]
    v_mfma_f32_32x32x16_bf16 v[80:95], v[44:47], v[168:171], v[80:95]
    v_mfma_f32_32x32x16_bf16 v[96:111], v[40:43], v[172:175], v[96:111]
    v_mfma_f32_32x32x16_bf16 v[112:127], v[44:47], v[172:175], v[112:127]
    s_waitcnt vmcnt(18) lgkmcnt(0)
    ds_read_b64_tr_b16 v[40:41], v18 offset:8192
    ds_read_b64_tr_b16 v[42:43], v18 offset:9216
    ds_read_b64_tr_b16 v[44:45], v19 offset:8192
    ds_read_b64_tr_b16 v[46:47], v19 offset:9216
    v_mfma_f32_32x32x16_bf16 v[64:79], v[32:35], v[176:179], v[64:79]
    v_mfma_f32_32x32x16_bf16 v[80:95], v[36:39], v[176:179], v[80:95]
    v_mfma_f32_32x32x16_bf16 v[96:111], v[32:35], v[180:183], v[96:111]
    v_mfma_f32_32x32x16_bf16 v[112:127], v[36:39], v[180:183], v[112:127]
    s_waitcnt vmcnt(16) lgkmcnt(0)
    v_mfma_f32_32x32x16_bf16 v[64:79], v[40:43], v[184:187], v[64:79]
    v_mfma_f32_32x32x16_bf16 v[80:95], v[44:47], v[184:187], v[80:95]
    v_mfma_f32_32x32x16_bf16 v[96:111], v[40:43], v[188:191], v[96:111]
    v_mfma_f32_32x32x16_bf16 v[112:127], v[44:47], v[188:191], v[112:127]
    s_setprio 3
    s_xor_b32 s42, s39, 0
    s_lshl_b32 s42, s42, 11
    v_add_u32 v26, s42, v2
    v_add_u32 v27, 98304, v26
    s_nop 7
    ds_write_b128 v27, v[96:99] offset:0
    ds_write_b128 v27, v[100:103] offset:1024
    ds_write_b128 v27, v[104:107] offset:8192
    ds_write_b128 v27, v[108:111] offset:9216
    ds_write_b128 v27, v[112:115] offset:49152
    ds_write_b128 v27, v[116:119] offset:50176
    ds_write_b128 v26, v[120:123] offset:32768
    ds_write_b128 v26, v[124:127] offset:33792
    s_xor_b32 s42, s39, 2
    s_lshl_b32 s42, s42, 11
    v_add_u32 v26, s42, v2
    v_add_u32 v27, 98304, v26
    v_mov_b32 v28, 155664
    v_mov_b32 v3, 1
    s_waitcnt vmcnt(0) lgkmcnt(0)
    s_mov_b64 exec, 1
    ds_add_u32 v28, v3
    s_mov_b64 exec, -1
gs1:
    ds_read_b32 v3, v28
    s_waitcnt lgkmcnt(0)
    v_readfirstlane_b32 s42, v3
    s_cmp_eq_u32 s42, 4
    s_cbranch_scc1 gs1_d
    s_sleep 1
    s_branch gs1
gs1_d:
    ds_read_b128 v[128:131], v27 offset:0
    ds_read_b128 v[132:135], v27 offset:1024
    ds_read_b128 v[136:139], v27 offset:8192
    ds_read_b128 v[140:143], v27 offset:9216
    ds_read_b128 v[144:147], v27 offset:49152
    ds_read_b128 v[148:151], v27 offset:50176
    ds_read_b128 v[152:155], v26 offset:32768
    ds_read_b128 v[156:159], v26 offset:33792
    s_waitcnt lgkmcnt(0)
    v_add_f32 v80, v80, v144
    v_add_f32 v81, v81, v145
    v_add_f32 v82, v82, v146
    v_add_f32 v83, v83, v147
    v_add_f32 v84, v84, v148
    v_add_f32 v85, v85, v149
    v_add_f32 v86, v86, v150
    v_add_f32 v87, v87, v151
    v_add_f32 v88, v88, v152
    v_add_f32 v89, v89, v153
    v_add_f32 v90, v90, v154
    v_add_f32 v91, v91, v155
    v_add_f32 v92, v92, v156
    v_add_f32 v93, v93, v157
    v_add_f32 v94, v94, v158
    v_add_f32 v95, v95, v159
    ds_write_b128 v27, v[80:83] offset:0
    ds_write_b128 v27, v[84:87] offset:1024
    ds_write_b128 v27, v[88:91] offset:8192
    ds_write_b128 v27, v[92:95] offset:9216
    v_add_f32 v64, v64, v128
    v_add_f32 v65, v65, v129
    v_add_f32 v66, v66, v130
    v_add_f32 v67, v67, v131
    v_add_f32 v68, v68, v132
    v_add_f32 v69, v69, v133
    v_add_f32 v70, v70, v134
    v_add_f32 v71, v71, v135
    v_add_f32 v72, v72, v136
    v_add_f32 v73, v73, v137
    v_add_f32 v74, v74, v138
    v_add_f32 v75, v75, v139
    v_add_f32 v76, v76, v140
    v_add_f32 v77, v77, v141
    v_add_f32 v78, v78, v142
    v_add_f32 v79, v79, v143
    s_xor_b32 s42, s39, 3
    s_lshl_b32 s42, s42, 11
    v_add_u32 v26, s42, v2
    v_add_u32 v27, 98304, v26
    v_mov_b32 v28, 155676
    v_mov_b32 v3, 1
    s_waitcnt vmcnt(0) lgkmcnt(0)
    s_mov_b64 exec, 1
    ds_add_u32 v28, v3
    s_mov_b64 exec, -1
gs2:
    ds_read_b32 v3, v28
    s_waitcnt lgkmcnt(0)
    v_readfirstlane_b32 s42, v3
    s_cmp_eq_u32 s42, 4
    s_cbranch_scc1 gs2_d
    s_sleep 1
    s_branch gs2
gs2_d:
    ds_read_b128 v[128:131], v27 offset:0
    ds_read_b128 v[132:135], v27 offset:1024
    ds_read_b128 v[136:139], v27 offset:8192
    ds_read_b128 v[140:143], v27 offset:9216
    v_sub_f32 v5, 1.0, v23
    s_lshl_b32 s43, s41, 1
    s_add_u32 s43, s43, s48
    s_lshl_b32 s47, s43, 9
    s_add_u32 s47, s47, 17039360
    s_lshl_b32 s45, s43, 15
    s_add_u32 s45, s45, 14680064
    s_mul_i32 s44, s43, 28672
    s_lshl_b32 s43, s3, 7
    s_add_u32 s44, s44, s43
    s_and_b32 s43, s39, 1
    s_lshl_b32 s43, s43, 6
    s_add_u32 s44, s44, s43
    v_and_b32 v25, 31, v1
    v_mul_u32_u24 v30, 896, v25
    v_lshrrev_b32 v6, 5, v1
    v_lshl_add_u32 v30, v6, 4, v30
    v_and_b32 v25, 0x1ff, v7
    s_mov_b32 s49, 0xffff0000
    s_mov_b32 s63, 1048576
    s_waitcnt lgkmcnt(0)
    v_add_f32 v64, v64, v128
    v_add_f32 v65, v65, v129
    v_add_f32 v66, v66, v130
    v_add_f32 v67, v67, v131
    v_add_f32 v68, v68, v132
    v_add_f32 v69, v69, v133
    v_add_f32 v70, v70, v134
    v_add_f32 v71, v71, v135
    v_add_f32 v72, v72, v136
    v_add_f32 v73, v73, v137
    v_add_f32 v74, v74, v138
    v_add_f32 v75, v75, v139
    v_add_f32 v76, v76, v140
    v_add_f32 v77, v77, v141
    v_add_f32 v78, v78, v142
    v_add_f32 v79, v79, v143
    v_mul_f32 v64, v64, v5
    v_mov_b32 v80, 0
    v_mul_f32 v65, v65, v5
    v_mov_b32 v81, 0
    v_mul_f32 v66, v66, v5
    v_mov_b32 v82, 0
    v_mul_f32 v67, v67, v5
    v_mov_b32 v83, 0
    v_mul_f32 v68, v68, v5
    v_mov_b32 v84, 0
    v_mul_f32 v69, v69, v5
    v_mov_b32 v85, 0
    v_mul_f32 v70, v70, v5
    v_mov_b32 v86, 0
    v_mul_f32 v71, v71, v5
    v_mov_b32 v87, 0
    v_mul_f32 v72, v72, v5
    v_mov_b32 v88, 0
    v_mul_f32 v73, v73, v5
    v_mov_b32 v89, 0
    v_mul_f32 v74, v74, v5
    v_mov_b32 v90, 0
    v_mul_f32 v75, v75, v5
    v_mov_b32 v91, 0
    v_mul_f32 v76, v76, v5
    v_mov_b32 v92, 0
    v_mul_f32 v77, v77, v5
    v_mov_b32 v93, 0
    v_mul_f32 v78, v78, v5
    v_mov_b32 v94, 0
    v_mul_f32 v79, v79, v5
    v_mov_b32 v95, 0
    s_setprio 1
    s_mov_b32 s53, 0
    s_mov_b32 s50, 0
p3_poll:
    buffer_load_dword v9, v25, s[20:23], s47 offen sc1
    s_cmp_eq_u32 s53, 0
    s_cbranch_scc1 p3_chk
    s_waitcnt vmcnt(1) lgkmcnt(0)
p3_run:
    v_mfma_f32_32x32x16_bf16 v[80:95], v[136:139], v[128:131], v[80:95]
    v_mfma_f32_32x32x16_bf16 v[80:95], v[140:143], v[132:135], v[80:95]
    s_cmp_eq_u32 s53, 1
    s_cbranch_scc1 p3_ran
    v_mfma_f32_32x32x16_bf16 v[80:95], v[152:155], v[144:147], v[80:95]
    v_mfma_f32_32x32x16_bf16 v[80:95], v[156:159], v[148:151], v[80:95]
    s_cmp_eq_u32 s53, 2
    s_cbranch_scc1 p3_ran
    v_mfma_f32_32x32x16_bf16 v[80:95], v[168:171], v[160:163], v[80:95]
    v_mfma_f32_32x32x16_bf16 v[80:95], v[172:175], v[164:167], v[80:95]
    s_cmp_eq_u32 s53, 3
    s_cbranch_scc1 p3_ran
    v_mfma_f32_32x32x16_bf16 v[80:95], v[184:187], v[176:179], v[80:95]
    v_mfma_f32_32x32x16_bf16 v[80:95], v[188:191], v[180:183], v[80:95]
    s_cmp_eq_u32 s53, 4
    s_cbranch_scc1 p3_ran
    v_mfma_f32_32x32x16_bf16 v[80:95], v[200:203], v[192:195], v[80:95]
    v_mfma_f32_32x32x16_bf16 v[80:95], v[204:207], v[196:199], v[80:95]
    s_cmp_eq_u32 s53, 5
    s_cbranch_scc1 p3_ran
    v_mfma_f32_32x32x16_bf16 v[80:95], v[216:219], v[208:211], v[80:95]
    v_mfma_f32_32x32x16_bf16 v[80:95], v[220:223], v[212:215], v[80:95]
    s_cmp_eq_u32 s53, 6
    s_cbranch_scc1 p3_ran
    v_mfma_f32_32x32x16_bf16 v[80:95], v[232:235], v[224:227], v[80:95]
    v_mfma_f32_32x32x16_bf16 v[80:95], v[236:239], v[228:231], v[80:95]
    s_cmp_eq_u32 s53, 7
    s_cbranch_scc1 p3_ran
    v_mfma_f32_32x32x16_bf16 v[80:95], v[248:251], v[240:243], v[80:95]
    v_mfma_f32_32x32x16_bf16 v[80:95], v[252:255], v[244:247], v[80:95]
p3_ran:
    s_mov_b32 s53, 0
    s_cmp_eq_u32 s49, -1
    s_cbranch_scc1 p3_fin
p3_chk:
    s_waitcnt vmcnt(0)
    v_cmp_eq_u32 vcc, s59, v9
    s_sub_u32 s63, s63, 1
    s_cbranch_scc1 p3_fin
    s_andn2_b32 s50, vcc_lo, s49
    s_cbranch_scc1 p3_batch
    s_sleep 2
    s_branch p3_poll
p3_batch:
    s_ff1_i32_b32 s52, s50
    s_bitset0_b32 s50, s52
    s_bitset1_b32 s49, s52
    s_lshl_b32 s42, s52, 11
    s_add_u32 s42, s42, s45
    buffer_load_dwordx4 v[128:131], v2, s[20:23], s42 offen sc1
    buffer_load_dwordx4 v[132:135], v2, s[20:23], s42 offen offset:1024 sc1
    s_bitcmp1_b32 s52, 1
    s_cselect_b32 s42, 0, 114688
    s_and_b32 s43, s52, 1
    s_lshl_b32 s43, s43, 14
    s_add_u32 s42, s42, s43
    s_lshr_b32 s43, s52, 2
    s_lshl_b32 s43, s43, 11
    s_add_u32 s42, s42, s43
    v_add_u32 v29, s42, v20
    ds_read_b64_tr_b16 v[136:137], v29
    ds_read_b64_tr_b16 v[138:139], v29 offset:1024
    ds_read_b64_tr_b16 v[140:141], v29 offset:8192
    ds_read_b64_tr_b16 v[142:143], v29 offset:9216
    s_mov_b32 s53, 1
    s_cmp_eq_u32 s50, 0
    s_cbranch_scc1 p3_iss
    s_ff1_i32_b32 s52, s50
    s_bitset0_b32 s50, s52
    s_bitset1_b32 s49, s52
    s_lshl_b32 s42, s52, 11
    s_add_u32 s42, s42, s45
    buffer_load_dwordx4 v[144:147], v2, s[20:23], s42 offen sc1
    buffer_load_dwordx4 v[148:151], v2, s[20:23], s42 offen offset:1024 sc1
    s_bitcmp1_b32 s52, 1
    s_cselect_b32 s42, 0, 114688
    s_and_b32 s43, s52, 1
    s_lshl_b32 s43, s43, 14
    s_add_u32 s42, s42, s43
    s_lshr_b32 s43, s52, 2
    s_lshl_b32 s43, s43, 11
    s_add_u32 s42, s42, s43
    v_add_u32 v29, s42, v20
    ds_read_b64_tr_b16 v[152:153], v29
    ds_read_b64_tr_b16 v[154:155], v29 offset:1024
    ds_read_b64_tr_b16 v[156:157], v29 offset:8192
    ds_read_b64_tr_b16 v[158:159], v29 offset:9216
    s_mov_b32 s53, 2
    s_cmp_eq_u32 s50, 0
    s_cbranch_scc1 p3_iss
    s_ff1_i32_b32 s52, s50
    s_bitset0_b32 s50, s52
    s_bitset1_b32 s49, s52
    s_lshl_b32 s42, s52, 11
    s_add_u32 s42, s42, s45
    buffer_load_dwordx4 v[160:163], v2, s[20:23], s42 offen sc1
    buffer_load_dwordx4 v[164:167], v2, s[20:23], s42 offen offset:1024 sc1
    s_bitcmp1_b32 s52, 1
    s_cselect_b32 s42, 0, 114688
    s_and_b32 s43, s52, 1
    s_lshl_b32 s43, s43, 14
    s_add_u32 s42, s42, s43
    s_lshr_b32 s43, s52, 2
    s_lshl_b32 s43, s43, 11
    s_add_u32 s42, s42, s43
    v_add_u32 v29, s42, v20
    ds_read_b64_tr_b16 v[168:169], v29
    ds_read_b64_tr_b16 v[170:171], v29 offset:1024
    ds_read_b64_tr_b16 v[172:173], v29 offset:8192
    ds_read_b64_tr_b16 v[174:175], v29 offset:9216
    s_mov_b32 s53, 3
    s_waitcnt lgkmcnt(8)
    s_cmp_eq_u32 s50, 0
    s_cbranch_scc1 p3_iss
    s_ff1_i32_b32 s52, s50
    s_bitset0_b32 s50, s52
    s_bitset1_b32 s49, s52
    s_lshl_b32 s42, s52, 11
    s_add_u32 s42, s42, s45
    buffer_load_dwordx4 v[176:179], v2, s[20:23], s42 offen sc1
    buffer_load_dwordx4 v[180:183], v2, s[20:23], s42 offen offset:1024 sc1
    s_bitcmp1_b32 s52, 1
    s_cselect_b32 s42, 0, 114688
    s_and_b32 s43, s52, 1
    s_lshl_b32 s43, s43, 14
    s_add_u32 s42, s42, s43
    s_lshr_b32 s43, s52, 2
    s_lshl_b32 s43, s43, 11
    s_add_u32 s42, s42, s43
    v_add_u32 v29, s42, v20
    ds_read_b64_tr_b16 v[184:185], v29
    ds_read_b64_tr_b16 v[186:187], v29 offset:1024
    ds_read_b64_tr_b16 v[188:189], v29 offset:8192
    ds_read_b64_tr_b16 v[190:191], v29 offset:9216
    s_mov_b32 s53, 4
    s_waitcnt lgkmcnt(8)
    s_cmp_eq_u32 s50, 0
    s_cbranch_scc1 p3_iss
    s_ff1_i32_b32 s52, s50
    s_bitset0_b32 s50, s52
    s_bitset1_b32 s49, s52
    s_lshl_b32 s42, s52, 11
    s_add_u32 s42, s42, s45
    buffer_load_dwordx4 v[192:195], v2, s[20:23], s42 offen sc1
    buffer_load_dwordx4 v[196:199], v2, s[20:23], s42 offen offset:1024 sc1
    s_bitcmp1_b32 s52, 1
    s_cselect_b32 s42, 0, 114688
    s_and_b32 s43, s52, 1
    s_lshl_b32 s43, s43, 14
    s_add_u32 s42, s42, s43
    s_lshr_b32 s43, s52, 2
    s_lshl_b32 s43, s43, 11
    s_add_u32 s42, s42, s43
    v_add_u32 v29, s42, v20
    ds_read_b64_tr_b16 v[200:201], v29
    ds_read_b64_tr_b16 v[202:203], v29 offset:1024
    ds_read_b64_tr_b16 v[204:205], v29 offset:8192
    ds_read_b64_tr_b16 v[206:207], v29 offset:9216
    s_mov_b32 s53, 5
    s_waitcnt lgkmcnt(8)
    s_cmp_eq_u32 s50, 0
    s_cbranch_scc1 p3_iss
    s_ff1_i32_b32 s52, s50
    s_bitset0_b32 s50, s52
    s_bitset1_b32 s49, s52
    s_lshl_b32 s42, s52, 11
    s_add_u32 s42, s42, s45
    buffer_load_dwordx4 v[208:211], v2, s[20:23], s42 offen sc1
    buffer_load_dwordx4 v[212:215], v2, s[20:23], s42 offen offset:1024 sc1
    s_bitcmp1_b32 s52, 1
    s_cselect_b32 s42, 0, 114688
    s_and_b32 s43, s52, 1
    s_lshl_b32 s43, s43, 14
    s_add_u32 s42, s42, s43
    s_lshr_b32 s43, s52, 2
    s_lshl_b32 s43, s43, 11
    s_add_u32 s42, s42, s43
    v_add_u32 v29, s42, v20
    ds_read_b64_tr_b16 v[216:217], v29
    ds_read_b64_tr_b16 v[218:219], v29 offset:1024
    ds_read_b64_tr_b16 v[220:221], v29 offset:8192
    ds_read_b64_tr_b16 v[222:223], v29 offset:9216
    s_mov_b32 s53, 6
    s_waitcnt lgkmcnt(8)
    s_cmp_eq_u32 s50, 0
    s_cbranch_scc1 p3_iss
    s_ff1_i32_b32 s52, s50
    s_bitset0_b32 s50, s52
    s_bitset1_b32 s49, s52
    s_lshl_b32 s42, s52, 11
    s_add_u32 s42, s42, s45
    buffer_load_dwordx4 v[224:227], v2, s[20:23], s42 offen sc1
    buffer_load_dwordx4 v[228:231], v2, s[20:23], s42 offen offset:1024 sc1
    s_bitcmp1_b32 s52, 1
    s_cselect_b32 s42, 0, 114688
    s_and_b32 s43, s52, 1
    s_lshl_b32 s43, s43, 14
    s_add_u32 s42, s42, s43
    s_lshr_b32 s43, s52, 2
    s_lshl_b32 s43, s43, 11
    s_add_u32 s42, s42, s43
    v_add_u32 v29, s42, v20
    ds_read_b64_tr_b16 v[232:233], v29
    ds_read_b64_tr_b16 v[234:235], v29 offset:1024
    ds_read_b64_tr_b16 v[236:237], v29 offset:8192
    ds_read_b64_tr_b16 v[238:239], v29 offset:9216
    s_mov_b32 s53, 7
    s_waitcnt lgkmcnt(8)
    s_cmp_eq_u32 s50, 0
    s_cbranch_scc1 p3_iss
    s_ff1_i32_b32 s52, s50
    s_bitset0_b32 s50, s52
    s_bitset1_b32 s49, s52
    s_lshl_b32 s42, s52, 11
    s_add_u32 s42, s42, s45
    buffer_load_dwordx4 v[240:243], v2, s[20:23], s42 offen sc1
    buffer_load_dwordx4 v[244:247], v2, s[20:23], s42 offen offset:1024 sc1
    s_bitcmp1_b32 s52, 1
    s_cselect_b32 s42, 0, 114688
    s_and_b32 s43, s52, 1
    s_lshl_b32 s43, s43, 14
    s_add_u32 s42, s42, s43
    s_lshr_b32 s43, s52, 2
    s_lshl_b32 s43, s43, 11
    s_add_u32 s42, s42, s43
    v_add_u32 v29, s42, v20
    ds_read_b64_tr_b16 v[248:249], v29
    ds_read_b64_tr_b16 v[250:251], v29 offset:1024
    ds_read_b64_tr_b16 v[252:253], v29 offset:8192
    ds_read_b64_tr_b16 v[254:255], v29 offset:9216
    s_mov_b32 s53, 8
    s_waitcnt lgkmcnt(8)
p3_iss:
    s_cmp_lg_u32 s49, -1
    s_cbranch_scc1 p3_poll
    s_waitcnt vmcnt(0) lgkmcnt(0)
    s_branch p3_run
p3_fin:
    s_nop 7
    s_nop 1
    v_fma_f32 v64, v80, v23, v64
    v_fma_f32 v65, v81, v23, v65
    v_fma_f32 v66, v82, v23, v66
    v_fma_f32 v67, v83, v23, v67
    v_fma_f32 v68, v84, v23, v68
    v_fma_f32 v69, v85, v23, v69
    v_fma_f32 v70, v86, v23, v70
    v_fma_f32 v71, v87, v23, v71
    v_fma_f32 v72, v88, v23, v72
    v_fma_f32 v73, v89, v23, v73
    v_fma_f32 v74, v90, v23, v74
    v_fma_f32 v75, v91, v23, v75
    v_fma_f32 v76, v92, v23, v76
    v_fma_f32 v77, v93, v23, v77
    v_fma_f32 v78, v94, v23, v78
    v_fma_f32 v79, v95, v23, v79
    v_cvt_pk_bf16_f32 v96, v64, v65
    v_cvt_pk_bf16_f32 v97, v66, v67
    v_cvt_pk_bf16_f32 v98, v68, v69
    v_cvt_pk_bf16_f32 v99, v70, v71
    v_cvt_pk_bf16_f32 v100, v72, v73
    v_cvt_pk_bf16_f32 v101, v74, v75
    v_cvt_pk_bf16_f32 v102, v76, v77
    v_cvt_pk_bf16_f32 v103, v78, v79
    v_permlane32_swap_b32 v96, v98
    v_permlane32_swap_b32 v97, v99
    buffer_store_dwordx4 v[96:99], v30, s[12:15], s44 offen
    v_permlane32_swap_b32 v100, v102
    v_permlane32_swap_b32 v101, v103
    buffer_store_dwordx4 v[100:103], v30, s[12:15], s44 offen offset:32
    s_endpgm
att_spin:
    s_cmp_lg_u32 s38, 0
    s_cbranch_scc1 aq_lw
    s_mov_b32 s63, 1048576
aq_ld:
    buffer_load_dword v9, v7, s[20:23], s56 offen sc1
    buffer_load_dword v10, v8, s[20:23], s56 offen sc1
aq_chk:
    s_waitcnt vmcnt(0)
    v_cmp_ne_u32 vcc, s59, v9
    v_cmp_ne_u32 s[16:17], s59, v10
    s_nop 0
    s_or_b32 s42, vcc_lo, s16
    s_cselect_b32 s42, 4, 5
    s_cmp_eq_u32 vcc_hi, 0
    s_cselect_b32 s43, 2, 0
    s_or_b32 s42, s42, s43
    s_sub_u32 s63, s63, 1
    s_cselect_b32 s42, 7, s42
    s_bitcmp1_b32 s42, 0
    s_cbranch_scc1 aq_ok
    s_sleep 2
    s_branch aq_ld
aq_ok:
    v_mov_b32 v3, 155652
    v_mov_b32 v4, s42
    ds_write_b32 v3, v4
    s_branch aq_go
aq_lw:
    v_mov_b32 v3, 155652
aq_lw2:
    ds_read_b32 v4, v3
    s_waitcnt lgkmcnt(0)
    v_readfirstlane_b32 s42, v4
    s_bitcmp1_b32 s42, 0
    s_cbranch_scc1 aq_go
    s_sleep 1
    s_branch aq_lw2
aq_go:
    s_mov_b32 s58, s42
    s_lshl_b32 s43, s57, 9
    s_lshl_b32 s44, s71, 2
    s_add_u32 s44, s44, s39
    s_mul_i32 s42, s44, 28672
    s_add_u32 s42, s42, s43
    buffer_load_dwordx4 v[16:19], v2, s[20:23], s42 offen sc1
    buffer_load_dwordx4 v[20:23], v2, s[20:23], s42 offen offset:1024 sc1
    s_mul_i32 s46, s39, 458752
    s_add_u32 s45, s46, s43
    s_add_u32 s45, s45, 2097152
    s_mul_i32 s42, s70, 448
    s_add_u32 s46, s46, s42
    s_add_u32 s46, s46, 4194304
    s_and_b32 s47, s71, 15
    s_mov_b32 s30, 0x0fffffff
    s_mov_b32 s31, 0x0fffffff
    v_lshrrev_b32 v14, 5, v1
    v_mul_u32_u24 v14, 6656, v14
    v_add_u32 v14, v14, v2
    v_add_u32 v11, 14336, v14
    s_add_u32 s42, s47, 0
    s_and_b32 s42, s42, 15
    s_mul_i32 s48, s42, 28672
    s_add_u32 s48, s48, s45
    buffer_load_dwordx4 v[144:147], v2, s[20:23], s48 offen offset:0 sc1
    buffer_load_dwordx4 v[148:151], v2, s[20:23], s48 offen offset:1024 sc1
    s_bitcmp1_b32 s58, 1
    s_cbranch_scc1 att_rp
    s_cmp_lg_u32 s38, 0
    s_cbranch_scc1 att_rp
    buffer_load_dword v9, v7, s[20:23], s56 offen sc1
    buffer_load_dword v10, v8, s[20:23], s56 offen sc1
att_rp:
    v_mov_b32 v60, 0
    v_mov_b32 v61, 0
    v_mov_b32 v152, 0x3f803f80
    v_mov_b32 v62, 0
    v_mov_b32 v63, 0
    v_mov_b32 v153, 0x3f803f80
    v_mov_b32 v64, 0
    v_mov_b32 v65, 0
    v_mov_b32 v154, 0x3f803f80
    v_mov_b32 v66, 0
    v_mov_b32 v67, 0
    v_mov_b32 v155, 0x3f803f80
    v_mov_b32 v68, 0
    v_mov_b32 v69, 0
    v_mov_b32 v156, 0x3f803f80
    v_mov_b32 v70, 0
    v_mov_b32 v71, 0
    v_mov_b32 v157, 0x3f803f80
    v_mov_b32 v72, 0
    v_mov_b32 v73, 0
    v_mov_b32 v158, 0x3f803f80
    v_mov_b32 v74, 0
    v_mov_b32 v75, 0
    v_mov_b32 v159, 0x3f803f80
    v_mov_b32 v76, 0
    v_mov_b32 v77, 0
    s_add_u32 s42, s47, 1
    v_mov_b32 v78, 0
    v_mov_b32 v79, 0
    s_and_b32 s42, s42, 15
    v_mov_b32 v80, 0
    v_mov_b32 v81, 0
    s_mul_i32 s48, s42, 28672
    v_mov_b32 v82, 0
    v_mov_b32 v83, 0
    s_add_u32 s48, s48, s45
    v_mov_b32 v84, 0
    v_mov_b32 v85, 0
    buffer_load_dwordx4 v[160:163], v2, s[20:23], s48 offen offset:0 sc1
    v_mov_b32 v86, 0
    v_mov_b32 v87, 0
    buffer_load_dwordx4 v[164:167], v2, s[20:23], s48 offen offset:1024 sc1
    v_mov_b32 v88, 0
    v_mov_b32 v89, 0
    v_mov_b32 v168, 0x3f803f80
    v_mov_b32 v90, 0
    v_mov_b32 v91, 0
    v_mov_b32 v169, 0x3f803f80
    v_mov_b32 v92, 0
    v_mov_b32 v93, 0
    v_mov_b32 v170, 0x3f803f80
    v_mov_b32 v94, 0
    v_mov_b32 v95, 0
    v_mov_b32 v171, 0x3f803f80
    v_mov_b32 v96, 0
    v_mov_b32 v97, 0
    v_mov_b32 v172, 0x3f803f80
    v_mov_b32 v98, 0
    v_mov_b32 v99, 0
    v_mov_b32 v173, 0x3f803f80
    v_mov_b32 v100, 0
    v_mov_b32 v101, 0
    v_mov_b32 v174, 0x3f803f80
    v_mov_b32 v102, 0
    v_mov_b32 v103, 0
    v_mov_b32 v175, 0x3f803f80
    v_mov_b32 v104, 0
    v_mov_b32 v105, 0
    s_add_u32 s42, s47, 2
    v_mov_b32 v106, 0
    v_mov_b32 v107, 0
    s_and_b32 s42, s42, 15
    v_mov_b32 v108, 0
    v_mov_b32 v109, 0
    s_mul_i32 s48, s42, 28672
    v_mov_b32 v110, 0
    v_mov_b32 v111, 0
    s_add_u32 s48, s48, s45
    buffer_load_dwordx4 v[176:179], v2, s[20:23], s48 offen offset:0 sc1
    buffer_load_dwordx4 v[180:183], v2, s[20:23], s48 offen offset:1024 sc1
    v_mov_b32 v184, 0x3f803f80
    v_mov_b32 v185, 0x3f803f80
    v_mov_b32 v186, 0x3f803f80
    v_mov_b32 v187, 0x3f803f80
    v_mov_b32 v188, 0x3f803f80
    v_mov_b32 v189, 0x3f803f80
    v_mov_b32 v190, 0x3f803f80
    v_mov_b32 v191, 0x3f803f80
    s_branch att_main2
att_main:
    v_mov_b32 v60, 0
    v_mov_b32 v61, 0
    v_mov_b32 v62, 0
    v_mov_b32 v63, 0
    v_mov_b32 v64, 0
    v_mov_b32 v65, 0
    v_mov_b32 v66, 0
    v_mov_b32 v67, 0
    v_mov_b32 v68, 0
    v_mov_b32 v69, 0
    v_mov_b32 v70, 0
    v_mov_b32 v71, 0
    v_mov_b32 v72, 0
    v_mov_b32 v73, 0
    v_mov_b32 v74, 0
    v_mov_b32 v75, 0
    v_mov_b32 v76, 0
    v_mov_b32 v77, 0
    v_mov_b32 v78, 0
    v_mov_b32 v79, 0
    v_mov_b32 v80, 0
    v_mov_b32 v81, 0
    v_mov_b32 v82, 0
    v_mov_b32 v83, 0
    v_mov_b32 v84, 0
    v_mov_b32 v85, 0
    v_mov_b32 v86, 0
    v_mov_b32 v87, 0
    v_mov_b32 v88, 0
    v_mov_b32 v89, 0
    v_mov_b32 v90, 0
    v_mov_b32 v91, 0
    v_mov_b32 v92, 0
    v_mov_b32 v93, 0
    v_mov_b32 v94, 0
    v_mov_b32 v95, 0
    v_mov_b32 v96, 0
    v_mov_b32 v97, 0
    v_mov_b32 v98, 0
    v_mov_b32 v99, 0
    v_mov_b32 v100, 0
    v_mov_b32 v101, 0
    v_mov_b32 v102, 0
    v_mov_b32 v103, 0
    v_mov_b32 v104, 0
    v_mov_b32 v105, 0
    v_mov_b32 v106, 0
    v_mov_b32 v107, 0
    v_mov_b32 v108, 0
    v_mov_b32 v109, 0
    v_mov_b32 v110, 0
    v_mov_b32 v111, 0
att_main2:
    s_bitcmp1_b32 s58, 1
    s_cbranch_scc1 att_lv
    s_cmp_lg_u32 s38, 0
    s_cbranch_scc1 att_rd
    s_waitcnt vmcnt(4)
    v_cmp_ne_u32 vcc, s59, v9
    v_cmp_ne_u32 s[16:17], s59, v10
    s_nop 0
    s_or_b32 s42, vcc_lo, s16
    s_cselect_b32 s42, 4, 5
    s_cmp_eq_u32 vcc_hi, 0
    s_cselect_b32 s43, 2, 0
    s_or_b32 s42, s42, s43
    v_mov_b32 v3, 155652
    v_mov_b32 v4, s42
    ds_write_b32 v3, v4
    s_mov_b32 s58, s42
    s_bitcmp1_b32 s58, 1
    s_cbranch_scc1 att_lv
    buffer_load_dword v9, v7, s[20:23], s56 offen sc1
    buffer_load_dword v10, v8, s[20:23], s56 offen sc1
    s_branch att_np
att_rd:
    v_mov_b32 v3, 155652
    ds_read_b32 v4, v3
    s_waitcnt lgkmcnt(0)
    v_readfirstlane_b32 s58, v4
    s_bitcmp1_b32 s58, 1
    s_cbranch_scc0 att_np
att_lv:
    s_mov_b64 exec, s[30:31]
    s_mul_i32 s52, s47, 28672
    s_add_u32 s52, s52, s46
    s_add_u32 s47, s47, 1
    s_and_b32 s47, s47, 15
    buffer_load_dwordx4 v[152:155], v14, s[20:23], s52 offen sc1
    buffer_load_dwordx4 v[156:159], v11, s[20:23], s52 offen sc1
    s_mul_i32 s52, s47, 28672
    s_add_u32 s52, s52, s46
    s_add_u32 s47, s47, 1
    s_and_b32 s47, s47, 15
    buffer_load_dwordx4 v[168:171], v14, s[20:23], s52 offen sc1
    buffer_load_dwordx4 v[172:175], v11, s[20:23], s52 offen sc1
    s_mul_i32 s52, s47, 28672
    s_add_u32 s52, s52, s46
    s_add_u32 s47, s47, 1
    s_and_b32 s47, s47, 15
    buffer_load_dwordx4 v[184:187], v14, s[20:23], s52 offen sc1
    buffer_load_dwordx4 v[188:191], v11, s[20:23], s52 offen sc1
    s_mov_b64 exec, -1
att_np:
    s_setprio 2
    s_lshl_b32 s42, s39, 11
    s_add_u32 s42, s42, 73728
    v_add_u32 v224, s42, v2
    v_subrev_u32 v225, 40960, v224
    ds_write_b128 v225, v[240:243]
    ds_write_b128 v225, v[244:247] offset:1024
    v_mov_b32 v4, 0
    s_and_b32 s42, s70, 1
    s_mov_b32 s24, 0
    s_mov_b32 s27, 0
    s_sub_u32 s25, s42, 1
    s_sub_u32 s26, 0, s42
    v_mov_b32 v216, 0x3f803f80
    v_mov_b32 v225, 155672
    v_mov_b32 v226, 1
    s_waitcnt vmcnt(10)
    s_bitcmp1_b32 s58, 1
    s_cbranch_scc1 att_w2
    s_waitcnt vmcnt(4)
att_w2:
    v_cndmask_b32 v16, v16, v4, s[26:27]
    v_cndmask_b32 v17, v17, v4, s[26:27]
    v_cndmask_b32 v22, v22, v4, s[24:25]
    v_cndmask_b32 v23, v23, v4, s[24:25]
    v_mfma_f32_32x32x16_bf16 v[128:143], v[144:147], v[16:19], 0
    s_nop 0
    v_mfma_f32_32x32x16_bf16 v[128:143], v[148:151], v[20:23], v[128:143]
    v_cndmask_b32 v150, v150, v216, s[24:25]
    v_cndmask_b32 v144, v144, v216, s[26:27]
    v_mov_b32 v48, 0
    v_mov_b32 v49, 0
    v_mov_b32 v50, 0
    v_mov_b32 v51, 0
    v_mov_b32 v52, 0
    v_mov_b32 v53, 0
    v_mov_b32 v54, 0
    v_mov_b32 v55, 0
    v_mov_b32 v56, 0
    v_mov_b32 v57, 0
    v_mov_b32 v58, 0
    v_mov_b32 v59, 0
    v_max3_f32 v15, v128, v129, v130
    v_max3_f32 v3, v131, v132, v133
    v_max3_f32 v5, v134, v135, v136
    v_max3_f32 v6, v137, v138, v139
    v_max3_f32 v15, v15, v140, v141
    v_max3_f32 v3, v3, v142, v143
    v_max3_f32 v15, v15, v5, v6
    v_max_f32 v15, v15, v3
    v_mov_b32 v3, v15
    s_nop 1
    v_permlane32_swap_b32 v15, v3
    v_max_f32 v15, v15, v3
    v_sub_f32 v15, 0, v15
    v_cvt_pk_bf16_f32 v3, v15, v15
    v_lshlrev_b32 v3, 16, v3
    v_sub_f32 v3, v15, v3
    v_cvt_pk_bf16_f32 v3, v15, v3
    v_cndmask_b32 v16, v16, v3, s[26:27]
    v_cndmask_b32 v22, v22, v3, s[24:25]
    ds_write_b128 v224, v[16:19]
    ds_write_b128 v224, v[20:23] offset:1024
    v_mfma_f32_32x32x16_bf16 v[112:127], v[144:147], v[16:19], 0
    v_mfma_f32_32x32x16_bf16 v[112:127], v[148:151], v[20:23], v[112:127]
    s_waitcnt lgkmcnt(0)
    s_mov_b64 exec, 1
    ds_add_u32 v225, v226
    s_mov_b64 exec, -1
    s_bitcmp1_b32 s58, 1
    s_cbranch_scc1 att_hv
    s_cmp_lg_u32 s38, 0
    s_cbranch_scc1 av_lw
    s_mov_b32 s63, 1048576
    s_branch av_chk
av_ld:
    buffer_load_dword v9, v7, s[20:23], s56 offen sc1
    buffer_load_dword v10, v8, s[20:23], s56 offen sc1
av_chk:
    s_waitcnt vmcnt(0)
    v_cmp_ne_u32 vcc, s59, v9
    v_cmp_ne_u32 s[16:17], s59, v10
    s_nop 0
    s_or_b32 s42, vcc_lo, s16
    s_cselect_b32 s42, 4, 5
    s_cmp_eq_u32 vcc_hi, 0
    s_cselect_b32 s43, 2, 0
    s_or_b32 s42, s42, s43
    s_sub_u32 s63, s63, 1
    s_cselect_b32 s42, 7, s42
    s_bitcmp1_b32 s42, 1
    s_cbranch_scc1 av_ok
    s_sleep 2
    s_branch av_ld
av_ok:
    v_mov_b32 v3, 155652
    v_mov_b32 v4, s42
    ds_write_b32 v3, v4
    s_branch av_go
av_lw:
    v_mov_b32 v3, 155652
av_lw2:
    ds_read_b32 v4, v3
    s_waitcnt lgkmcnt(0)
    v_readfirstlane_b32 s42, v4
    s_bitcmp1_b32 s42, 1
    s_cbranch_scc1 av_go
    s_sleep 1
    s_branch av_lw2
av_go:
    s_mov_b64 exec, s[30:31]
    s_mul_i32 s52, s47, 28672
    s_add_u32 s52, s52, s46
    s_add_u32 s47, s47, 1
    s_and_b32 s47, s47, 15
    buffer_load_dwordx4 v[152:155], v14, s[20:23], s52 offen sc1
    buffer_load_dwordx4 v[156:159], v11, s[20:23], s52 offen sc1
    s_mul_i32 s52, s47, 28672
    s_add_u32 s52, s52, s46
    s_add_u32 s47, s47, 1
    s_and_b32 s47, s47, 15
    buffer_load_dwordx4 v[168:171], v14, s[20:23], s52 offen sc1
    buffer_load_dwordx4 v[172:175], v11, s[20:23], s52 offen sc1
    s_mul_i32 s52, s47, 28672
    s_add_u32 s52, s52, s46
    s_add_u32 s47, s47, 1
    s_and_b32 s47, s47, 15
    buffer_load_dwordx4 v[184:187], v14, s[20:23], s52 offen sc1
    buffer_load_dwordx4 v[188:191], v11, s[20:23], s52 offen sc1
att_hv:
    s_mov_b64 exec, 1
    ds_add_u32 v225, v226 offset:12
    s_mov_b64 exec, -1
    s_mul_i32 s52, s47, 28672
    s_add_u32 s48, s52, s45
    s_add_u32 s52, s52, s46
    v_mov_b32 v212, 0
    v_mov_b32 v204, v216
    v_mov_b32 v200, v216
    v_mov_b32 v213, 0
    v_mov_b32 v205, v216
    v_mov_b32 v201, v216
    v_mov_b32 v214, 0
    v_mov_b32 v206, v216
    v_mov_b32 v202, v216
    v_mov_b32 v215, 0
    v_mov_b32 v207, v216
    v_mov_b32 v203, v216
    s_add_u32 s42, s39, 1
    s_and_b32 s42, s42, 3
    s_lshl_b32 s42, s42, 11
    s_add_u32 s42, s42, 73728
    v_add_u32 v227, s42, v2
    s_add_u32 s42, s39, 1
    s_and_b32 s42, s42, 3
    s_mul_i32 s42, s42, 12288
    s_add_u32 s42, s42, 49152
    v_add_u32 v232, s42, v2
    s_add_u32 s42, s39, 2
    s_and_b32 s42, s42, 3
    s_lshl_b32 s42, s42, 11
    s_add_u32 s42, s42, 73728
    v_add_u32 v228, s42, v2
    s_add_u32 s42, s39, 2
    s_and_b32 s42, s42, 3
    s_mul_i32 s42, s42, 12288
    s_add_u32 s42, s42, 53248
    v_add_u32 v233, s42, v2
    s_add_u32 s42, s39, 3
    s_and_b32 s42, s42, 3
    s_lshl_b32 s42, s42, 11
    s_add_u32 s42, s42, 73728
    v_add_u32 v229, s42, v2
    s_add_u32 s42, s39, 3
    s_and_b32 s42, s42, 3
    s_mul_i32 s42, s42, 12288
    s_add_u32 s42, s42, 57344
    v_add_u32 v234, s42, v2
    s_mul_i32 s42, s39, 12288
    s_add_u32 s42, s42, 49152
    v_add_u32 v235, s42, v2
    v_mov_b32 v236, 155648
    v_mov_b32 v237, 1
att_qsync:
    ds_read_b32 v226, v225
    s_waitcnt lgkmcnt(0)
    v_cmp_gt_u32 vcc, 4, v226
    s_cbranch_vccnz att_qsync
    ds_read_b128 v[24:27], v227
    ds_read_b128 v[28:31], v227 offset:1024
    ds_read_b128 v[32:35], v228
    ds_read_b128 v[36:39], v228 offset:1024
    ds_read_b128 v[40:43], v229
    ds_read_b128 v[44:47], v229 offset:1024
    s_waitcnt vmcnt(2) lgkmcnt(0)
    s_mov_b32 s49, 0
att_loop:
    v_exp_f32 v112, v112
    v_exp_f32 v113, v113
    v_mfma_f32_32x32x16_bf16 v[96:111], v[204:207], v[212:215], v[96:111]
    s_add_u32 s47, s47, 1
    v_exp_f32 v114, v114
    v_exp_f32 v115, v115
    v_exp_f32 v116, v116
    v_mfma_f32_32x32x16_bf16 v[128:143], v[144:147], v[24:27], 0
    buffer_load_dwordx4 v[192:195], v2, s[20:23], s48 offen offset:0 sc1
    v_exp_f32 v117, v117
    v_exp_f32 v118, v118
    v_exp_f32 v119, v119
    v_exp_f32 v120, v120
    v_cvt_pk_bf16_f32 v208, v112, v113
    v_cvt_pk_bf16_f32 v209, v114, v115
    v_cvt_pk_bf16_f32 v210, v116, v117
    v_cvt_pk_bf16_f32 v211, v118, v119
    v_mfma_f32_32x32x16_bf16 v[128:143], v[148:151], v[28:31], v[128:143]
    s_waitcnt vmcnt(9)
    v_exp_f32 v121, v121
    v_exp_f32 v122, v122
    v_exp_f32 v123, v123
    v_mfma_f32_32x32x16_bf16 v[48:63], v[152:155], v[208:211], v[48:63]
    s_and_b32 s47, s47, 15
    v_exp_f32 v124, v124
    v_exp_f32 v125, v125
    v_exp_f32 v126, v126
    v_exp_f32 v127, v127
    v_cvt_pk_bf16_f32 v212, v120, v121
    v_cvt_pk_bf16_f32 v213, v122, v123
    v_cvt_pk_bf16_f32 v214, v124, v125
    v_cvt_pk_bf16_f32 v215, v126, v127
    v_exp_f32 v128, v128
    v_exp_f32 v129, v129
    v_mfma_f32_32x32x16_bf16 v[48:63], v[156:159], v[212:215], v[48:63]
    s_cmp_eq_u32 s49, 3
    v_exp_f32 v130, v130
    v_exp_f32 v131, v131
    v_exp_f32 v132, v132
    v_mfma_f32_32x32x16_bf16 v[112:127], v[144:147], v[32:35], 0
    buffer_load_dwordx4 v[196:199], v2, s[20:23], s48 offen offset:1024 sc1
    v_exp_f32 v133, v133
    v_exp_f32 v134, v134
    v_exp_f32 v135, v135
    v_exp_f32 v136, v136
    v_cvt_pk_bf16_f32 v208, v128, v129
    v_cvt_pk_bf16_f32 v209, v130, v131
    v_cvt_pk_bf16_f32 v210, v132, v133
    v_cvt_pk_bf16_f32 v211, v134, v135
    v_mfma_f32_32x32x16_bf16 v[112:127], v[148:151], v[36:39], v[112:127]
    s_cselect_b32 s45, 1073741824, s45
    v_exp_f32 v137, v137
    v_exp_f32 v138, v138
    v_exp_f32 v139, v139
    v_mfma_f32_32x32x16_bf16 v[64:79], v[152:155], v[208:211], v[64:79]
    s_cselect_b32 s46, 1073741824, s46
    v_exp_f32 v140, v140
    v_exp_f32 v141, v141
    v_exp_f32 v142, v142
    v_exp_f32 v143, v143
    v_cvt_pk_bf16_f32 v212, v136, v137
    v_cvt_pk_bf16_f32 v213, v138, v139
    v_cvt_pk_bf16_f32 v214, v140, v141
    v_cvt_pk_bf16_f32 v215, v142, v143
    v_exp_f32 v112, v112
    v_exp_f32 v113, v113
    v_mfma_f32_32x32x16_bf16 v[64:79], v[156:159], v[212:215], v[64:79]
    s_mul_i32 s42, s47, 28672
    v_exp_f32 v114, v114
    v_exp_f32 v115, v115
    v_exp_f32 v116, v116
    v_mfma_f32_32x32x16_bf16 v[128:143], v[144:147], v[40:43], 0
    s_mov_b64 exec, s[30:31]
    buffer_load_dwordx4 v[200:203], v14, s[20:23], s52 offen sc1
    s_mov_b64 exec, -1
    v_exp_f32 v117, v117
    v_exp_f32 v118, v118
    v_exp_f32 v119, v119
    v_exp_f32 v120, v120
    v_cvt_pk_bf16_f32 v208, v112, v113
    v_cvt_pk_bf16_f32 v209, v114, v115
    v_cvt_pk_bf16_f32 v210, v116, v117
    v_cvt_pk_bf16_f32 v211, v118, v119
    v_mfma_f32_32x32x16_bf16 v[128:143], v[148:151], v[44:47], v[128:143]
    s_add_u32 s48, s42, s45
    v_exp_f32 v121, v121
    v_exp_f32 v122, v122
    v_exp_f32 v123, v123
    v_mfma_f32_32x32x16_bf16 v[80:95], v[152:155], v[208:211], v[80:95]
    s_waitcnt vmcnt(9)
    v_exp_f32 v124, v124
    v_exp_f32 v125, v125
    v_exp_f32 v126, v126
    v_exp_f32 v127, v127
    v_cndmask_b32 v166, v166, v216, s[24:25]
    v_cndmask_b32 v160, v160, v216, s[26:27]
    v_cvt_pk_bf16_f32 v212, v120, v121
    v_cvt_pk_bf16_f32 v213, v122, v123
    v_cvt_pk_bf16_f32 v214, v124, v125
    v_cvt_pk_bf16_f32 v215, v126, v127
    v_exp_f32 v128, v128
    v_exp_f32 v129, v129
    v_mfma_f32_32x32x16_bf16 v[80:95], v[156:159], v[212:215], v[80:95]
    v_exp_f32 v130, v130
    v_exp_f32 v131, v131
    v_exp_f32 v132, v132
    v_mfma_f32_32x32x16_bf16 v[112:127], v[160:163], v[16:19], 0
    s_mov_b64 exec, s[30:31]
    buffer_load_dwordx4 v[204:207], v11, s[20:23], s52 offen sc1
    s_mov_b64 exec, -1
    v_exp_f32 v133, v133
    v_exp_f32 v134, v134
    v_exp_f32 v135, v135
    v_exp_f32 v136, v136
    v_cvt_pk_bf16_f32 v208, v128, v129
    v_cvt_pk_bf16_f32 v209, v130, v131
    v_cvt_pk_bf16_f32 v210, v132, v133
    v_cvt_pk_bf16_f32 v211, v134, v135
    v_mfma_f32_32x32x16_bf16 v[112:127], v[164:167], v[20:23], v[112:127]
    s_add_u32 s52, s42, s46
    v_exp_f32 v137, v137
    v_exp_f32 v138, v138
    v_exp_f32 v139, v139
    v_mfma_f32_32x32x16_bf16 v[96:111], v[152:155], v[208:211], v[96:111]
    v_exp_f32 v140, v140
    v_exp_f32 v141, v141
    v_exp_f32 v142, v142
    v_exp_f32 v143, v143
    v_cvt_pk_bf16_f32 v212, v136, v137
    v_cvt_pk_bf16_f32 v213, v138, v139
    v_cvt_pk_bf16_f32 v214, v140, v141
    v_cvt_pk_bf16_f32 v215, v142, v143
    v_exp_f32 v112, v112
    v_exp_f32 v113, v113
    v_mfma_f32_32x32x16_bf16 v[96:111], v[156:159], v[212:215], v[96:111]
    s_add_u32 s47, s47, 1
    v_exp_f32 v114, v114
    v_exp_f32 v115, v115
    v_exp_f32 v116, v116
    v_mfma_f32_32x32x16_bf16 v[128:143], v[160:163], v[24:27], 0
    buffer_load_dwordx4 v[144:147], v2, s[20:23], s48 offen offset:0 sc1
    v_exp_f32 v117, v117
    v_exp_f32 v118, v118
    v_exp_f32 v119, v119
    v_exp_f32 v120, v120
    v_cvt_pk_bf16_f32 v208, v112, v113
    v_cvt_pk_bf16_f32 v209, v114, v115
    v_cvt_pk_bf16_f32 v210, v116, v117
    v_cvt_pk_bf16_f32 v211, v118, v119
    v_mfma_f32_32x32x16_bf16 v[128:143], v[164:167], v[28:31], v[128:143]
    s_waitcnt vmcnt(9)
    v_exp_f32 v121, v121
    v_exp_f32 v122, v122
    v_exp_f32 v123, v123
    v_mfma_f32_32x32x16_bf16 v[48:63], v[168:171], v[208:211], v[48:63]
    s_and_b32 s47, s47, 15
    v_exp_f32 v124, v124
    v_exp_f32 v125, v125
    v_exp_f32 v126, v126
    v_exp_f32 v127, v127
    v_cvt_pk_bf16_f32 v212, v120, v121
    v_cvt_pk_bf16_f32 v213, v122, v123
    v_cvt_pk_bf16_f32 v214, v124, v125
    v_cvt_pk_bf16_f32 v215, v126, v127
    v_exp_f32 v128, v128
    v_exp_f32 v129, v129
    v_mfma_f32_32x32x16_bf16 v[48:63], v[172:175], v[212:215], v[48:63]
    v_exp_f32 v130, v130
    v_exp_f32 v131, v131
    v_exp_f32 v132, v132
    v_mfma_f32_32x32x16_bf16 v[112:127], v[160:163], v[32:35], 0
    buffer_load_dwordx4 v[148:151], v2, s[20:23], s48 offen offset:1024 sc1
    v_exp_f32 v133, v133
    v_exp_f32 v134, v134
    v_exp_f32 v135, v135
    v_exp_f32 v136, v136
    v_cvt_pk_bf16_f32 v208, v128, v129
    v_cvt_pk_bf16_f32 v209, v130, v131
    v_cvt_pk_bf16_f32 v210, v132, v133
    v_cvt_pk_bf16_f32 v211, v134, v135
    v_mfma_f32_32x32x16_bf16 v[112:127], v[164:167], v[36:39], v[112:127]
    v_exp_f32 v137, v137
    v_exp_f32 v138, v138
    v_exp_f32 v139, v139
    v_mfma_f32_32x32x16_bf16 v[64:79], v[168:171], v[208:211], v[64:79]
    v_exp_f32 v140, v140
    v_exp_f32 v141, v141
    v_exp_f32 v142, v142
    v_exp_f32 v143, v143
    v_cvt_pk_bf16_f32 v212, v136, v137
    v_cvt_pk_bf16_f32 v213, v138, v139
    v_cvt_pk_bf16_f32 v214, v140, v141
    v_cvt_pk_bf16_f32 v215, v142, v143
    v_exp_f32 v112, v112
    v_exp_f32 v113, v113
    v_mfma_f32_32x32x16_bf16 v[64:79], v[172:175], v[212:215], v[64:79]
    s_mul_i32 s42, s47, 28672
    v_exp_f32 v114, v114
    v_exp_f32 v115, v115
    v_exp_f32 v116, v116
    v_mfma_f32_32x32x16_bf16 v[128:143], v[160:163], v[40:43], 0
    s_mov_b64 exec, s[30:31]
    buffer_load_dwordx4 v[152:155], v14, s[20:23], s52 offen sc1
    s_mov_b64 exec, -1
    v_exp_f32 v117, v117
    v_exp_f32 v118, v118
    v_exp_f32 v119, v119
    v_exp_f32 v120, v120
    v_cvt_pk_bf16_f32 v208, v112, v113
    v_cvt_pk_bf16_f32 v209, v114, v115
    v_cvt_pk_bf16_f32 v210, v116, v117
    v_cvt_pk_bf16_f32 v211, v118, v119
    v_mfma_f32_32x32x16_bf16 v[128:143], v[164:167], v[44:47], v[128:143]
    s_add_u32 s48, s42, s45
    v_exp_f32 v121, v121
    v_exp_f32 v122, v122
    v_exp_f32 v123, v123
    v_mfma_f32_32x32x16_bf16 v[80:95], v[168:171], v[208:211], v[80:95]
    s_waitcnt vmcnt(9)
    v_exp_f32 v124, v124
    v_exp_f32 v125, v125
    v_exp_f32 v126, v126
    v_exp_f32 v127, v127
    v_cndmask_b32 v182, v182, v216, s[24:25]
    v_cndmask_b32 v176, v176, v216, s[26:27]
    v_cvt_pk_bf16_f32 v212, v120, v121
    v_cvt_pk_bf16_f32 v213, v122, v123
    v_cvt_pk_bf16_f32 v214, v124, v125
    v_cvt_pk_bf16_f32 v215, v126, v127
    v_exp_f32 v128, v128
    v_exp_f32 v129, v129
    v_mfma_f32_32x32x16_bf16 v[80:95], v[172:175], v[212:215], v[80:95]
    v_exp_f32 v130, v130
    v_exp_f32 v131, v131
    v_exp_f32 v132, v132
    v_mfma_f32_32x32x16_bf16 v[112:127], v[176:179], v[16:19], 0
    s_mov_b64 exec, s[30:31]
    buffer_load_dwordx4 v[156:159], v11, s[20:23], s52 offen sc1
    s_mov_b64 exec, -1
    v_exp_f32 v133, v133
    v_exp_f32 v134, v134
    v_exp_f32 v135, v135
    v_exp_f32 v136, v136
    v_cvt_pk_bf16_f32 v208, v128, v129
    v_cvt_pk_bf16_f32 v209, v130, v131
    v_cvt_pk_bf16_f32 v210, v132, v133
    v_cvt_pk_bf16_f32 v211, v134, v135
    v_mfma_f32_32x32x16_bf16 v[112:127], v[180:183], v[20:23], v[112:127]
    s_add_u32 s52, s42, s46
    v_exp_f32 v137, v137
    v_exp_f32 v138, v138
    v_exp_f32 v139, v139
    v_mfma_f32_32x32x16_bf16 v[96:111], v[168:171], v[208:211], v[96:111]
    v_exp_f32 v140, v140
    v_exp_f32 v141, v141
    v_exp_f32 v142, v142
    v_exp_f32 v143, v143
    v_cvt_pk_bf16_f32 v212, v136, v137
    v_cvt_pk_bf16_f32 v213, v138, v139
    v_cvt_pk_bf16_f32 v214, v140, v141
    v_cvt_pk_bf16_f32 v215, v142, v143
    v_exp_f32 v112, v112
    v_exp_f32 v113, v113
    v_mfma_f32_32x32x16_bf16 v[96:111], v[172:175], v[212:215], v[96:111]
    s_add_u32 s47, s47, 1
    v_exp_f32 v114, v114
    v_exp_f32 v115, v115
    v_exp_f32 v116, v116
    v_mfma_f32_32x32x16_bf16 v[128:143], v[176:179], v[24:27], 0
    buffer_load_dwordx4 v[160:163], v2, s[20:23], s48 offen offset:0 sc1
    v_exp_f32 v117, v117
    v_exp_f32 v118, v118
    v_exp_f32 v119, v119
    v_exp_f32 v120, v120
    v_cvt_pk_bf16_f32 v208, v112, v113
    v_cvt_pk_bf16_f32 v209, v114, v115
    v_cvt_pk_bf16_f32 v210, v116, v117
    v_cvt_pk_bf16_f32 v211, v118, v119
    v_mfma_f32_32x32x16_bf16 v[128:143], v[180:183], v[28:31], v[128:143]
    s_waitcnt vmcnt(9)
    v_exp_f32 v121, v121
    v_exp_f32 v122, v122
    v_exp_f32 v123, v123
    v_mfma_f32_32x32x16_bf16 v[48:63], v[184:187], v[208:211], v[48:63]
    s_and_b32 s47, s47, 15
    v_exp_f32 v124, v124
    v_exp_f32 v125, v125
    v_exp_f32 v126, v126
    v_exp_f32 v127, v127
    v_cvt_pk_bf16_f32 v212, v120, v121
    v_cvt_pk_bf16_f32 v213, v122, v123
    v_cvt_pk_bf16_f32 v214, v124, v125
    v_cvt_pk_bf16_f32 v215, v126, v127
    v_exp_f32 v128, v128
    v_exp_f32 v129, v129
    v_mfma_f32_32x32x16_bf16 v[48:63], v[188:191], v[212:215], v[48:63]
    v_exp_f32 v130, v130
    v_exp_f32 v131, v131
    v_exp_f32 v132, v132
    v_mfma_f32_32x32x16_bf16 v[112:127], v[176:179], v[32:35], 0
    buffer_load_dwordx4 v[164:167], v2, s[20:23], s48 offen offset:1024 sc1
    v_exp_f32 v133, v133
    v_exp_f32 v134, v134
    v_exp_f32 v135, v135
    v_exp_f32 v136, v136
    v_cvt_pk_bf16_f32 v208, v128, v129
    v_cvt_pk_bf16_f32 v209, v130, v131
    v_cvt_pk_bf16_f32 v210, v132, v133
    v_cvt_pk_bf16_f32 v211, v134, v135
    v_mfma_f32_32x32x16_bf16 v[112:127], v[180:183], v[36:39], v[112:127]
    v_exp_f32 v137, v137
    v_exp_f32 v138, v138
    v_exp_f32 v139, v139
    v_mfma_f32_32x32x16_bf16 v[64:79], v[184:187], v[208:211], v[64:79]
    v_exp_f32 v140, v140
    v_exp_f32 v141, v141
    v_exp_f32 v142, v142
    v_exp_f32 v143, v143
    v_cvt_pk_bf16_f32 v212, v136, v137
    v_cvt_pk_bf16_f32 v213, v138, v139
    v_cvt_pk_bf16_f32 v214, v140, v141
    v_cvt_pk_bf16_f32 v215, v142, v143
    v_exp_f32 v112, v112
    v_exp_f32 v113, v113
    v_mfma_f32_32x32x16_bf16 v[64:79], v[188:191], v[212:215], v[64:79]
    s_mul_i32 s42, s47, 28672
    v_exp_f32 v114, v114
    v_exp_f32 v115, v115
    v_exp_f32 v116, v116
    v_mfma_f32_32x32x16_bf16 v[128:143], v[176:179], v[40:43], 0
    s_mov_b64 exec, s[30:31]
    buffer_load_dwordx4 v[168:171], v14, s[20:23], s52 offen sc1
    s_mov_b64 exec, -1
    v_exp_f32 v117, v117
    v_exp_f32 v118, v118
    v_exp_f32 v119, v119
    v_exp_f32 v120, v120
    v_cvt_pk_bf16_f32 v208, v112, v113
    v_cvt_pk_bf16_f32 v209, v114, v115
    v_cvt_pk_bf16_f32 v210, v116, v117
    v_cvt_pk_bf16_f32 v211, v118, v119
    v_mfma_f32_32x32x16_bf16 v[128:143], v[180:183], v[44:47], v[128:143]
    s_add_u32 s48, s42, s45
    v_exp_f32 v121, v121
    v_exp_f32 v122, v122
    v_exp_f32 v123, v123
    v_mfma_f32_32x32x16_bf16 v[80:95], v[184:187], v[208:211], v[80:95]
    s_waitcnt vmcnt(9)
    s_cmp_eq_u32 s49, 3
    v_exp_f32 v124, v124
    v_exp_f32 v125, v125
    v_exp_f32 v126, v126
    v_exp_f32 v127, v127
    v_cndmask_b32 v198, v198, v216, s[24:25]
    v_cndmask_b32 v192, v192, v216, s[26:27]
    v_cvt_pk_bf16_f32 v212, v120, v121
    v_cvt_pk_bf16_f32 v213, v122, v123
    v_cvt_pk_bf16_f32 v214, v124, v125
    v_cvt_pk_bf16_f32 v215, v126, v127
    s_cbranch_scc1 att_peel
    v_exp_f32 v128, v128
    v_exp_f32 v129, v129
    v_mfma_f32_32x32x16_bf16 v[80:95], v[188:191], v[212:215], v[80:95]
    v_exp_f32 v130, v130
    v_exp_f32 v131, v131
    v_exp_f32 v132, v132
    v_mfma_f32_32x32x16_bf16 v[112:127], v[192:195], v[16:19], 0
    s_mov_b64 exec, s[30:31]
    buffer_load_dwordx4 v[172:175], v11, s[20:23], s52 offen sc1
    s_mov_b64 exec, -1
    v_exp_f32 v133, v133
    v_exp_f32 v134, v134
    v_exp_f32 v135, v135
    v_exp_f32 v136, v136
    v_cvt_pk_bf16_f32 v208, v128, v129
    v_cvt_pk_bf16_f32 v209, v130, v131
    v_cvt_pk_bf16_f32 v210, v132, v133
    v_cvt_pk_bf16_f32 v211, v134, v135
    v_mfma_f32_32x32x16_bf16 v[112:127], v[196:199], v[20:23], v[112:127]
    s_add_u32 s52, s42, s46
    v_exp_f32 v137, v137
    v_exp_f32 v138, v138
    v_exp_f32 v139, v139
    v_mfma_f32_32x32x16_bf16 v[96:111], v[184:187], v[208:211], v[96:111]
    v_exp_f32 v140, v140
    v_exp_f32 v141, v141
    v_exp_f32 v142, v142
    v_exp_f32 v143, v143
    v_cvt_pk_bf16_f32 v212, v136, v137
    v_cvt_pk_bf16_f32 v213, v138, v139
    v_cvt_pk_bf16_f32 v214, v140, v141
    v_cvt_pk_bf16_f32 v215, v142, v143
    v_exp_f32 v112, v112
    v_exp_f32 v113, v113
    v_mfma_f32_32x32x16_bf16 v[96:111], v[188:191], v[212:215], v[96:111]
    s_add_u32 s47, s47, 1
    v_exp_f32 v114, v114
    v_exp_f32 v115, v115
    v_exp_f32 v116, v116
    v_mfma_f32_32x32x16_bf16 v[128:143], v[192:195], v[24:27], 0
    buffer_load_dwordx4 v[176:179], v2, s[20:23], s48 offen offset:0 sc1
    v_exp_f32 v117, v117
    v_exp_f32 v118, v118
    v_exp_f32 v119, v119
    v_exp_f32 v120, v120
    v_cvt_pk_bf16_f32 v208, v112, v113
    v_cvt_pk_bf16_f32 v209, v114, v115
    v_cvt_pk_bf16_f32 v210, v116, v117
    v_cvt_pk_bf16_f32 v211, v118, v119
    v_mfma_f32_32x32x16_bf16 v[128:143], v[196:199], v[28:31], v[128:143]
    s_waitcnt vmcnt(9)
    v_exp_f32 v121, v121
    v_exp_f32 v122, v122
    v_exp_f32 v123, v123
    v_mfma_f32_32x32x16_bf16 v[48:63], v[200:203], v[208:211], v[48:63]
    s_and_b32 s47, s47, 15
    v_exp_f32 v124, v124
    v_exp_f32 v125, v125
    v_exp_f32 v126, v126
    v_exp_f32 v127, v127
    v_cvt_pk_bf16_f32 v212, v120, v121
    v_cvt_pk_bf16_f32 v213, v122, v123
    v_cvt_pk_bf16_f32 v214, v124, v125
    v_cvt_pk_bf16_f32 v215, v126, v127
    v_exp_f32 v128, v128
    v_exp_f32 v129, v129
    v_mfma_f32_32x32x16_bf16 v[48:63], v[204:207], v[212:215], v[48:63]
    v_exp_f32 v130, v130
    v_exp_f32 v131, v131
    v_exp_f32 v132, v132
    v_mfma_f32_32x32x16_bf16 v[112:127], v[192:195], v[32:35], 0
    buffer_load_dwordx4 v[180:183], v2, s[20:23], s48 offen offset:1024 sc1
    v_exp_f32 v133, v133
    v_exp_f32 v134, v134
    v_exp_f32 v135, v135
    v_exp_f32 v136, v136
    v_cvt_pk_bf16_f32 v208, v128, v129
    v_cvt_pk_bf16_f32 v209, v130, v131
    v_cvt_pk_bf16_f32 v210, v132, v133
    v_cvt_pk_bf16_f32 v211, v134, v135
    v_mfma_f32_32x32x16_bf16 v[112:127], v[196:199], v[36:39], v[112:127]
    v_exp_f32 v137, v137
    v_exp_f32 v138, v138
    v_exp_f32 v139, v139
    v_mfma_f32_32x32x16_bf16 v[64:79], v[200:203], v[208:211], v[64:79]
    s_add_u32 s49, s49, 1
    v_exp_f32 v140, v140
    v_exp_f32 v141, v141
    v_exp_f32 v142, v142
    v_exp_f32 v143, v143
    v_cvt_pk_bf16_f32 v212, v136, v137
    v_cvt_pk_bf16_f32 v213, v138, v139
    v_cvt_pk_bf16_f32 v214, v140, v141
    v_cvt_pk_bf16_f32 v215, v142, v143
    v_exp_f32 v112, v112
    v_exp_f32 v113, v113
    v_mfma_f32_32x32x16_bf16 v[64:79], v[204:207], v[212:215], v[64:79]
    s_mul_i32 s42, s47, 28672
    v_exp_f32 v114, v114
    v_exp_f32 v115, v115
    v_exp_f32 v116, v116
    v_mfma_f32_32x32x16_bf16 v[128:143], v[192:195], v[40:43], 0
    s_mov_b64 exec, s[30:31]
    buffer_load_dwordx4 v[184:187], v14, s[20:23], s52 offen sc1
    s_mov_b64 exec, -1
    v_exp_f32 v117, v117
    v_exp_f32 v118, v118
    v_exp_f32 v119, v119
    v_exp_f32 v120, v120
    v_cvt_pk_bf16_f32 v208, v112, v113
    v_cvt_pk_bf16_f32 v209, v114, v115
    v_cvt_pk_bf16_f32 v210, v116, v117
    v_cvt_pk_bf16_f32 v211, v118, v119
    v_mfma_f32_32x32x16_bf16 v[128:143], v[196:199], v[44:47], v[128:143]
    s_add_u32 s48, s42, s45
    v_exp_f32 v121, v121
    v_exp_f32 v122, v122
    v_exp_f32 v123, v123
    v_mfma_f32_32x32x16_bf16 v[80:95], v[200:203], v[208:211], v[80:95]
    s_waitcnt vmcnt(9)
    v_exp_f32 v124, v124
    v_exp_f32 v125, v125
    v_exp_f32 v126, v126
    v_exp_f32 v127, v127
    v_cndmask_b32 v150, v150, v216, s[24:25]
    v_cndmask_b32 v144, v144, v216, s[26:27]
    v_cvt_pk_bf16_f32 v212, v120, v121
    v_cvt_pk_bf16_f32 v213, v122, v123
    v_cvt_pk_bf16_f32 v214, v124, v125
    v_cvt_pk_bf16_f32 v215, v126, v127
    v_exp_f32 v128, v128
    v_exp_f32 v129, v129
    v_mfma_f32_32x32x16_bf16 v[80:95], v[204:207], v[212:215], v[80:95]
    v_exp_f32 v130, v130
    v_exp_f32 v131, v131
    v_exp_f32 v132, v132
    v_mfma_f32_32x32x16_bf16 v[112:127], v[144:147], v[16:19], 0
    s_mov_b64 exec, s[30:31]
    buffer_load_dwordx4 v[188:191], v11, s[20:23], s52 offen sc1
    s_mov_b64 exec, -1
    v_exp_f32 v133, v133
    v_exp_f32 v134, v134
    v_exp_f32 v135, v135
    v_exp_f32 v136, v136
    v_cvt_pk_bf16_f32 v208, v128, v129
    v_cvt_pk_bf16_f32 v209, v130, v131
    v_cvt_pk_bf16_f32 v210, v132, v133
    v_cvt_pk_bf16_f32 v211, v134, v135
    v_mfma_f32_32x32x16_bf16 v[112:127], v[148:151], v[20:23], v[112:127]
    s_add_u32 s52, s42, s46
    v_exp_f32 v137, v137
    v_exp_f32 v138, v138
    v_exp_f32 v139, v139
    v_mfma_f32_32x32x16_bf16 v[96:111], v[200:203], v[208:211], v[96:111]
    v_exp_f32 v140, v140
    v_exp_f32 v141, v141
    v_exp_f32 v142, v142
    v_exp_f32 v143, v143
    v_cvt_pk_bf16_f32 v212, v136, v137
    v_cvt_pk_bf16_f32 v213, v138, v139
    v_cvt_pk_bf16_f32 v214, v140, v141
    v_cvt_pk_bf16_f32 v215, v142, v143
    s_branch att_loop
att_peel:
    v_exp_f32 v128, v128
    v_exp_f32 v129, v129
    v_mfma_f32_32x32x16_bf16 v[80:95], v[188:191], v[212:215], v[80:95]
    s_lshl_b32 s44, s71, 2
    v_exp_f32 v130, v130
    v_exp_f32 v131, v131
    v_exp_f32 v132, v132
    v_mfma_f32_32x32x16_bf16 v[112:127], v[192:195], v[24:27], 0
    s_add_u32 s44, s44, s39
    v_exp_f32 v133, v133
    v_exp_f32 v134, v134
    v_exp_f32 v135, v135
    v_exp_f32 v136, v136
    v_cvt_pk_bf16_f32 v208, v128, v129
    v_cvt_pk_bf16_f32 v209, v130, v131
    v_cvt_pk_bf16_f32 v210, v132, v133
    v_cvt_pk_bf16_f32 v211, v134, v135
    v_mfma_f32_32x32x16_bf16 v[112:127], v[196:199], v[28:31], v[112:127]
    s_lshl_b32 s44, s44, 4
    v_exp_f32 v137, v137
    v_exp_f32 v138, v138
    v_exp_f32 v139, v139
    v_mfma_f32_32x32x16_bf16 v[96:111], v[184:187], v[208:211], v[96:111]
    s_add_u32 s44, s44, s70
    v_exp_f32 v140, v140
    v_exp_f32 v141, v141
    v_exp_f32 v142, v142
    v_exp_f32 v143, v143
    v_cvt_pk_bf16_f32 v212, v136, v137
    v_cvt_pk_bf16_f32 v213, v138, v139
    v_cvt_pk_bf16_f32 v214, v140, v141
    v_cvt_pk_bf16_f32 v215, v142, v143
    v_exp_f32 v112, v112
    v_exp_f32 v113, v113
    v_mfma_f32_32x32x16_bf16 v[96:111], v[188:191], v[212:215], v[96:111]
    s_lshl_b32 s45, s44, 11
    v_exp_f32 v114, v114
    v_exp_f32 v115, v115
    v_exp_f32 v116, v116
    v_mfma_f32_32x32x16_bf16 v[128:143], v[192:195], v[32:35], 0
    s_add_u32 s45, s45, 14680064
    v_exp_f32 v117, v117
    v_exp_f32 v118, v118
    v_exp_f32 v119, v119
    v_exp_f32 v120, v120
    v_cvt_pk_bf16_f32 v208, v112, v113
    v_cvt_pk_bf16_f32 v209, v114, v115
    v_cvt_pk_bf16_f32 v210, v116, v117
    v_cvt_pk_bf16_f32 v211, v118, v119
    v_mfma_f32_32x32x16_bf16 v[128:143], v[196:199], v[36:39], v[128:143]
    s_waitcnt vmcnt(0)
    v_exp_f32 v121, v121
    v_exp_f32 v122, v122
    v_exp_f32 v123, v123
    v_mfma_f32_32x32x16_bf16 v[64:79], v[200:203], v[208:211], v[64:79]
    s_lshr_b32 s46, s44, 2
    v_exp_f32 v124, v124
    v_exp_f32 v125, v125
    v_exp_f32 v126, v126
    v_exp_f32 v127, v127
    v_cvt_pk_bf16_f32 v212, v120, v121
    v_cvt_pk_bf16_f32 v213, v122, v123
    v_cvt_pk_bf16_f32 v214, v124, v125
    v_cvt_pk_bf16_f32 v215, v126, v127
    v_exp_f32 v128, v128
    v_exp_f32 v129, v129
    v_mfma_f32_32x32x16_bf16 v[64:79], v[204:207], v[212:215], v[64:79]
    s_lshl_b32 s46, s46, 7
    v_exp_f32 v130, v130
    v_exp_f32 v131, v131
    v_exp_f32 v132, v132
    v_mfma_f32_32x32x16_bf16 v[112:127], v[192:195], v[40:43], 0
    s_and_b32 s44, s44, 3
    v_exp_f32 v133, v133
    v_exp_f32 v134, v134
    v_exp_f32 v135, v135
    v_exp_f32 v136, v136
    v_cvt_pk_bf16_f32 v208, v128, v129
    v_cvt_pk_bf16_f32 v209, v130, v131
    v_cvt_pk_bf16_f32 v210, v132, v133
    v_cvt_pk_bf16_f32 v211, v134, v135
    v_mfma_f32_32x32x16_bf16 v[112:127], v[196:199], v[44:47], v[112:127]
    ds_write_b128 v232, v[64:67] offset:0
    ds_write_b128 v232, v[68:71] offset:1024
    v_exp_f32 v137, v137
    v_exp_f32 v138, v138
    v_exp_f32 v139, v139
    v_mfma_f32_32x32x16_bf16 v[80:95], v[200:203], v[208:211], v[80:95]
    ds_write_b128 v232, v[72:75] offset:2048
    ds_write_b128 v232, v[76:79] offset:3072
    v_exp_f32 v140, v140
    v_exp_f32 v141, v141
    v_exp_f32 v142, v142
    v_exp_f32 v143, v143
    v_cvt_pk_bf16_f32 v212, v136, v137
    v_cvt_pk_bf16_f32 v213, v138, v139
    v_cvt_pk_bf16_f32 v214, v140, v141
    v_cvt_pk_bf16_f32 v215, v142, v143
    v_exp_f32 v112, v112
    v_exp_f32 v113, v113
    v_mfma_f32_32x32x16_bf16 v[80:95], v[204:207], v[212:215], v[80:95]
    s_lshl_b32 s44, s44, 2
    v_exp_f32 v114, v114
    v_exp_f32 v115, v115
    v_exp_f32 v116, v116
    v_mfma_f32_32x32x16_bf16 v[128:143], v[192:195], v[16:19], 0
    s_add_u32 s46, s46, s44
    v_exp_f32 v117, v117
    v_exp_f32 v118, v118
    v_exp_f32 v119, v119
    v_exp_f32 v120, v120
    v_cvt_pk_bf16_f32 v208, v112, v113
    v_cvt_pk_bf16_f32 v209, v114, v115
    v_cvt_pk_bf16_f32 v210, v116, v117
    v_cvt_pk_bf16_f32 v211, v118, v119
    v_mfma_f32_32x32x16_bf16 v[128:143], v[196:199], v[20:23], v[128:143]
    ds_write_b128 v233, v[80:83] offset:0
    ds_write_b128 v233, v[84:87] offset:1024
    v_exp_f32 v121, v121
    v_exp_f32 v122, v122
    v_exp_f32 v123, v123
    v_mfma_f32_32x32x16_bf16 v[96:111], v[200:203], v[208:211], v[96:111]
    ds_write_b128 v233, v[88:91] offset:2048
    ds_write_b128 v233, v[92:95] offset:3072
    v_exp_f32 v124, v124
    v_exp_f32 v125, v125
    v_exp_f32 v126, v126
    v_exp_f32 v127, v127
    v_cvt_pk_bf16_f32 v212, v120, v121
    v_cvt_pk_bf16_f32 v213, v122, v123
    v_cvt_pk_bf16_f32 v214, v124, v125
    v_cvt_pk_bf16_f32 v215, v126, v127
    v_exp_f32 v128, v128
    v_exp_f32 v129, v129
    v_mfma_f32_32x32x16_bf16 v[96:111], v[204:207], v[212:215], v[96:111]
    s_add_u32 s46, s46, 17039360
    s_mov_b32 s42, 0x3a800000
    s_mov_b32 s43, 0x71800000
    v_exp_f32 v130, v130
    v_exp_f32 v131, v131
    v_exp_f32 v132, v132
    v_exp_f32 v133, v133
    v_exp_f32 v134, v134
    v_exp_f32 v135, v135
    v_exp_f32 v136, v136
    v_cvt_pk_bf16_f32 v208, v128, v129
    v_cvt_pk_bf16_f32 v209, v130, v131
    v_cvt_pk_bf16_f32 v210, v132, v133
    v_cvt_pk_bf16_f32 v211, v134, v135
    s_nop 0
    ds_write_b128 v234, v[96:99] offset:0
    ds_write_b128 v234, v[100:103] offset:1024
    ds_write_b128 v234, v[104:107] offset:2048
    ds_write_b128 v234, v[108:111] offset:3072
    v_exp_f32 v137, v137
    v_exp_f32 v138, v138
    v_exp_f32 v139, v139
    v_mfma_f32_32x32x16_bf16 v[48:63], v[200:203], v[208:211], v[48:63]
    v_exp_f32 v140, v140
    v_exp_f32 v141, v141
    v_exp_f32 v142, v142
    v_exp_f32 v143, v143
    s_waitcnt lgkmcnt(0)
    s_mov_b64 exec, 1
    ds_add_u32 v236, v237
    s_mov_b64 exec, -1
    v_cvt_pk_bf16_f32 v212, v136, v137
    v_cvt_pk_bf16_f32 v213, v138, v139
    v_cvt_pk_bf16_f32 v214, v140, v141
    v_cvt_pk_bf16_f32 v215, v142, v143
    v_cmp_lt_u32 s[18:19], 31, v1
    s_nop 0
    v_mfma_f32_32x32x16_bf16 v[48:63], v[204:207], v[212:215], v[48:63]
att_msync:
    ds_read_b32 v5, v236
    s_waitcnt lgkmcnt(0)
    v_cmp_gt_u32 vcc, 4, v5
    s_cbranch_vccnz att_msync
    ds_read_b128 v[64:67], v235 offset:0
    ds_read_b128 v[68:71], v235 offset:1024
    ds_read_b128 v[72:75], v235 offset:2048
    ds_read_b128 v[76:79], v235 offset:3072
    ds_read_b128 v[80:83], v235 offset:4096
    ds_read_b128 v[84:87], v235 offset:5120
    ds_read_b128 v[88:91], v235 offset:6144
    ds_read_b128 v[92:95], v235 offset:7168
    ds_read_b128 v[96:99], v235 offset:8192
    ds_read_b128 v[100:103], v235 offset:9216
    ds_read_b128 v[104:107], v235 offset:10240
    ds_read_b128 v[108:111], v235 offset:11264
    s_mov_b64 vcc, s[18:19]
    s_waitcnt lgkmcnt(8)
    v_add_f32 v48, v48, v64
    v_add_f32 v49, v49, v65
    v_add_f32 v50, v50, v66
    v_add_f32 v51, v51, v67
    v_add_f32 v52, v52, v68
    v_add_f32 v53, v53, v69
    v_add_f32 v54, v54, v70
    v_add_f32 v55, v55, v71
    v_add_f32 v56, v56, v72
    v_add_f32 v57, v57, v73
    v_add_f32 v58, v58, v74
    v_add_f32 v59, v59, v75
    v_add_f32 v60, v60, v76
    v_add_f32 v61, v61, v77
    v_add_f32 v62, v62, v78
    v_add_f32 v63, v63, v79
    s_waitcnt lgkmcnt(4)
    v_add_f32 v48, v48, v80
    v_add_f32 v49, v49, v81
    v_add_f32 v50, v50, v82
    v_add_f32 v51, v51, v83
    v_add_f32 v52, v52, v84
    v_add_f32 v53, v53, v85
    v_add_f32 v54, v54, v86
    v_add_f32 v55, v55, v87
    v_add_f32 v56, v56, v88
    v_add_f32 v57, v57, v89
    v_add_f32 v58, v58, v90
    v_add_f32 v59, v59, v91
    v_add_f32 v60, v60, v92
    v_add_f32 v61, v61, v93
    v_add_f32 v62, v62, v94
    v_add_f32 v63, v63, v95
    s_waitcnt lgkmcnt(0)
    v_add_f32 v48, v48, v96
    v_add_f32 v49, v49, v97
    v_add_f32 v50, v50, v98
    v_add_f32 v51, v51, v99
    v_add_f32 v52, v52, v100
    v_add_f32 v53, v53, v101
    v_add_f32 v54, v54, v102
    v_add_f32 v55, v55, v103
    v_add_f32 v56, v56, v104
    v_add_f32 v57, v57, v105
    v_add_f32 v58, v58, v106
    v_add_f32 v59, v59, v107
    v_add_f32 v60, v60, v108
    v_add_f32 v61, v61, v109
    v_add_f32 v62, v62, v110
    v_add_f32 v63, v63, v111
    v_mov_b32 v3, v60
    v_mov_b32 v4, v60
    v_mul_f32 v64, 0, v48
    v_mul_f32 v65, 0, v52
    v_mul_f32 v66, 0, v56
    v_mul_f32 v67, 0, v60
    v_permlane32_swap_b32 v3, v4
    v_fma_f32 v64, v49, 0, v64
    v_fma_f32 v65, v53, 0, v65
    v_fma_f32 v66, v57, 0, v66
    v_fma_f32 v67, v61, 0, v67
    v_fma_f32 v64, v50, 0, v64
    v_fma_f32 v65, v54, 0, v65
    v_fma_f32 v66, v58, 0, v66
    v_fma_f32 v67, v62, 0, v67
    v_fma_f32 v64, v51, 0, v64
    v_fma_f32 v65, v55, 0, v65
    v_fma_f32 v66, v59, 0, v66
    v_fma_f32 v67, v63, 0, v67
    v_rcp_f32 v5, v4
    v_add_f32 v64, v64, v65
    v_add_f32 v66, v66, v67
    v_add_f32 v64, v64, v4
    v_add_f32 v64, v64, v66
    v_cmp_le_f32 s[28:29], s42, v64
    v_cmp_ge_f32 s[16:17], s43, v64
    s_and_b64 s[28:29], s[28:29], s[16:17]
    s_cmp_eq_u64 s[28:29], -1
    s_cbranch_scc0 att_fallback
att_final:
    v_mov_b32 v3, 0
    v_mul_f32 v48, v48, v5
    v_mul_f32 v49, v49, v5
    v_mul_f32 v50, v50, v5
    v_mul_f32 v51, v51, v5
    v_mul_f32 v52, v52, v5
    v_mul_f32 v53, v53, v5
    v_mul_f32 v54, v54, v5
    v_mul_f32 v55, v55, v5
    v_cvt_pk_bf16_f32 v224, v48, v49
    v_cvt_pk_bf16_f32 v225, v50, v51
    v_cvt_pk_bf16_f32 v226, v52, v53
    v_cvt_pk_bf16_f32 v227, v54, v55
    buffer_store_dwordx4 v[224:227], v2, s[20:23], s45 offen offset:0 sc1
    v_mul_f32 v56, v56, v5
    v_mul_f32 v57, v57, v5
    v_mul_f32 v58, v58, v5
    v_mul_f32 v59, v59, v5
    v_mul_f32 v60, v60, v5
    v_mul_f32 v61, v61, v5
    v_mul_f32 v62, v62, v5
    v_mul_f32 v63, v63, v5
    v_cvt_pk_bf16_f32 v228, v56, v57
    v_cvt_pk_bf16_f32 v229, v58, v59
    v_cvt_pk_bf16_f32 v230, v60, v61
    v_cvt_pk_bf16_f32 v231, v62, v63
    v_cndmask_b32 v230, v230, v3, vcc
    v_cndmask_b32 v231, v231, v3, vcc
    buffer_store_dwordx4 v[228:231], v2, s[20:23], s45 offen offset:1024 sc1
    s_waitcnt vmcnt(0)
    buffer_store_dword v13, v12, s[20:23], s46 offen sc1
    s_endpgm
att_fallback:
    v_mov_b32 v3, 0
    v_mov_b32 v224, 0xff800000
    v_cndmask_b32 v16, v16, v3, s[26:27]
    v_cndmask_b32 v22, v22, v3, s[24:25]
    s_mov_b32 s49, 0
    s_lshl_b32 s48, s57, 9
    s_add_u32 s48, s48, 2097152
    s_mul_i32 s52, s70, 448
    s_add_u32 s52, s52, 4194304
    s_waitcnt vmcnt(0)
    v_mov_b32 v48, 0
    v_mov_b32 v49, 0
    v_mov_b32 v50, 0
    v_mov_b32 v51, 0
    v_mov_b32 v52, 0
    v_mov_b32 v53, 0
    v_mov_b32 v54, 0
    v_mov_b32 v55, 0
    v_mov_b32 v56, 0
    v_mov_b32 v57, 0
    v_mov_b32 v58, 0
    v_mov_b32 v59, 0
    v_mov_b32 v60, 0
    v_mov_b32 v61, 0
    v_mov_b32 v62, 0
    v_mov_b32 v63, 0
att_fb_loop:
    buffer_load_dwordx4 v[144:147], v2, s[20:23], s48 offen sc1
    buffer_load_dwordx4 v[148:151], v2, s[20:23], s48 offen offset:1024 sc1
    s_mov_b64 exec, s[30:31]
    buffer_load_dwordx4 v[152:155], v14, s[20:23], s52 offen sc1
    buffer_load_dwordx4 v[156:159], v11, s[20:23], s52 offen sc1
    s_mov_b64 exec, -1
    s_waitcnt vmcnt(0)
    v_mfma_f32_32x32x16_bf16 v[112:127], v[144:147], v[16:19], 0
    v_mfma_f32_32x32x16_bf16 v[112:127], v[148:151], v[20:23], v[112:127]
    s_nop 15
    v_max3_f32 v225, v224, v112, v113
    v_max3_f32 v225, v225, v114, v115
    v_max3_f32 v225, v225, v116, v117
    v_max3_f32 v225, v225, v118, v119
    v_max3_f32 v225, v225, v120, v121
    v_max3_f32 v225, v225, v122, v123
    v_max3_f32 v225, v225, v124, v125
    v_max3_f32 v225, v225, v126, v127
    v_mov_b32 v3, v225
    s_nop 1
    v_permlane32_swap_b32 v225, v3
    v_max_f32 v225, v225, v3
    v_sub_f32 v226, v224, v225
    v_exp_f32 v226, v226
    v_mov_b32 v224, v225
    v_sub_f32 v112, v112, v225
    v_sub_f32 v113, v113, v225
    v_sub_f32 v114, v114, v225
    v_sub_f32 v115, v115, v225
    v_sub_f32 v116, v116, v225
    v_sub_f32 v117, v117, v225
    v_sub_f32 v118, v118, v225
    v_sub_f32 v119, v119, v225
    v_sub_f32 v120, v120, v225
    v_sub_f32 v121, v121, v225
    v_sub_f32 v122, v122, v225
    v_sub_f32 v123, v123, v225
    v_sub_f32 v124, v124, v225
    v_sub_f32 v125, v125, v225
    v_sub_f32 v126, v126, v225
    v_sub_f32 v127, v127, v225
    v_exp_f32 v112, v112
    v_exp_f32 v113, v113
    v_exp_f32 v114, v114
    v_exp_f32 v115, v115
    v_exp_f32 v116, v116
    v_exp_f32 v117, v117
    v_exp_f32 v118, v118
    v_exp_f32 v119, v119
    v_exp_f32 v120, v120
    v_exp_f32 v121, v121
    v_exp_f32 v122, v122
    v_exp_f32 v123, v123
    v_exp_f32 v124, v124
    v_exp_f32 v125, v125
    v_exp_f32 v126, v126
    v_exp_f32 v127, v127
    v_mul_f32 v48, v48, v226
    v_mul_f32 v49, v49, v226
    v_mul_f32 v50, v50, v226
    v_mul_f32 v51, v51, v226
    v_mul_f32 v52, v52, v226
    v_mul_f32 v53, v53, v226
    v_mul_f32 v54, v54, v226
    v_mul_f32 v55, v55, v226
    v_mul_f32 v56, v56, v226
    v_mul_f32 v57, v57, v226
    v_mul_f32 v58, v58, v226
    v_mul_f32 v59, v59, v226
    v_mul_f32 v60, v60, v226
    v_mul_f32 v61, v61, v226
    v_mul_f32 v62, v62, v226
    v_mul_f32 v63, v63, v226
    v_cvt_pk_bf16_f32 v208, v112, v113
    v_cvt_pk_bf16_f32 v209, v114, v115
    v_cvt_pk_bf16_f32 v210, v116, v117
    v_cvt_pk_bf16_f32 v211, v118, v119
    v_cvt_pk_bf16_f32 v212, v120, v121
    v_cvt_pk_bf16_f32 v213, v122, v123
    v_cvt_pk_bf16_f32 v214, v124, v125
    v_cvt_pk_bf16_f32 v215, v126, v127
    s_nop 1
    v_mfma_f32_32x32x16_bf16 v[48:63], v[152:155], v[208:211], v[48:63]
    v_mfma_f32_32x32x16_bf16 v[48:63], v[156:159], v[212:215], v[48:63]
    s_add_u32 s48, s48, 28672
    s_add_u32 s52, s52, 28672
    s_add_u32 s49, s49, 1
    s_cmp_lt_u32 s49, 64
    s_cbranch_scc1 att_fb_loop
    s_nop 15
    v_mov_b32 v3, v60
    v_mov_b32 v4, v60
    s_nop 1
    v_permlane32_swap_b32 v3, v4
    v_rcp_f32 v5, v4
    s_nop 0
    s_branch att_final
k_end:
    s_endpgm
.section .rodata,"a"
.p2align 6
.amdhsa_kernel gated_mix__softmax_full_mha__swiglu_ffn__prompt_kernel
  .amdhsa_next_free_vgpr 256
  .amdhsa_next_free_sgpr 102
  .amdhsa_accum_offset 256
  .amdhsa_group_segment_fixed_size 0
  .amdhsa_kernarg_size 88
  .amdhsa_user_sgpr_count 2
  .amdhsa_user_sgpr_kernarg_segment_ptr 1
  .amdhsa_system_sgpr_workgroup_id_x 1
.end_amdhsa_kernel
```
